```python
import torch

def _softmax(x, axis=-1):
    return torch.softmax(x, dim=axis)
def _gelu(x):
    return torch.nn.functional.gelu(x, approximate="tanh")
def _silu(x):
    return torch.nn.functional.silu(x)
def _sigmoid(x):
    return torch.sigmoid(x)
def _layernorm(x, axis=-1, eps=1e-5):
    m = x.mean(dim=axis, keepdim=True)
    v = x.var(dim=axis, keepdim=True, unbiased=False)
    return (x - m) / torch.sqrt(v + eps)
def _scatter_add(tgt, idx, src, axis=0):
    return tgt.clone().index_add_(axis, idx, src)
def _segment_sum(src, seg, n):
    out = torch.zeros((n,) + src.shape[1:], dtype=src.dtype)
    return out.index_add_(0, seg, src)
def _pad(x, pw):
    flat = tuple(v for pair in reversed(pw) for v in pair)
    return torch.nn.functional.pad(x, flat)

kernel_name = 'gated_mix__ssm_conv_s4d__dense_activation_silu__prompt'

def setup_inputs():

    _w = (lambda a: (lambda t: t.to(torch.bfloat16) if t.is_floating_point() else t)(torch.as_tensor(a)))
    def _A_setup():
        Bsz, L, D, N = 1, 2048, 640, 128
        return {
            "u": _w((lambda *s: torch.randn(*s, dtype=torch.bfloat16) * 0.05)(Bsz, L, D)),
            "log_A_real": _w((lambda *s: torch.randn(*s, dtype=torch.bfloat16) * 3.2)(D, N) * 0.5),
            "A_imag": _w((lambda *s: torch.randn(*s, dtype=torch.bfloat16) * 0.05)(D, N) * 3.14),
            "C_real": _w((lambda *s: torch.randn(*s, dtype=torch.bfloat16) * 0.1)(D, N) / N ** 0.5),
            "C_imag": _w((lambda *s: torch.randn(*s, dtype=torch.bfloat16) * 0.1)(D, N) / N ** 0.5),
            "log_dt": _w((lambda *s: torch.randn(*s, dtype=torch.bfloat16) * 0.05)(D) * 0.5 - 4.0),
            "D_skip": _w((lambda *s: torch.randn(*s, dtype=torch.bfloat16) * 0.05)(D)),
        }
    _A_in = _A_setup()

    def _B_setup():
        B, S, D, F = 1, 2048, 640, 1728
        return {
            "x": _w((lambda *s: torch.randn(*s, dtype=torch.bfloat16) * 0.05)(B, S, D)),
            "w1": _w((lambda *s: torch.randn(*s, dtype=torch.bfloat16) * 3.2)(D, F) * (D ** -0.5)),
            "w2": _w((lambda *s: torch.randn(*s, dtype=torch.bfloat16) * 0.1)(F, D) * (F ** -0.5)),
        }
    _B_in = _B_setup()

    return {
        "A_u": _A_in["u"],
        "A_log_A_real": _A_in["log_A_real"],
        "A_A_imag": _A_in["A_imag"],
        "A_C_real": _A_in["C_real"],
        "A_C_imag": _A_in["C_imag"],
        "A_log_dt": _A_in["log_dt"],
        "A_D_skip": _A_in["D_skip"],
        "B_x": _B_in["x"],
        "B_w1": _B_in["w1"],
        "B_w2": _B_in["w2"],
        "gate_w": _w((lambda *s: torch.randn(*s, dtype=torch.bfloat16) * 0.05)(640) * 16.0),
    }

def reference(A_u, A_log_A_real, A_A_imag, A_C_real, A_C_imag, A_log_dt, A_D_skip, B_x, B_w1, B_w2, gate_w):
    def _A_ref(u, log_A_real, A_imag, C_real, C_imag, log_dt, D_skip):
        L = u.shape[1]
        dt = torch.exp(log_dt)
        A = -torch.exp(log_A_real) + 1j * A_imag
        C = (C_real + 1j * C_imag) * dt[:, None]
        pos = (lambda x, dt: x.to(dt))(torch.arange(L), log_dt.dtype)
        P = torch.exp((A * dt[:, None])[:, :, None] * pos[None, None, :])
        K = 2.0 * torch.einsum("dn,dnl->dl", C, P).real
        L2 = 2 * L
        u_t = (lambda x, *d: x.permute(*d))(u, 0, 2, 1)
        Kf = (lambda x, *a, **k: torch.fft.rfft(x.float(), *a, **k))(K, L2)
        Uf = (lambda x, *a, **k: torch.fft.rfft(x.float(), *a, **k))(u_t, L2)
        y = (lambda x, *a, **k: torch.fft.irfft(x, *a, **k).to(torch.bfloat16))(Uf * Kf[None, :, :], L2)[:, :, :L]
        y = (lambda x, *d: x.permute(*d))(y, 0, 2, 1)
        return y + u * D_skip[None, None, :]

    def _B_ref(x, w1, w2):
        h = torch.einsum("bsd,df->bsf", x, w1)
        h = _silu(h)
        out = torch.einsum("bsf,fd->bsd", h, w2)
        return out

    x = A_u
    g = _sigmoid((x * gate_w).sum(-1, keepdims=True))
    a = _A_ref(x, A_log_A_real, A_A_imag, A_C_real, A_C_imag, A_log_dt, A_D_skip)
    b = _B_ref(x, B_w1, B_w2)
    return g * a + (1 - g) * b
```

```asm
; @launch kernel=k1_kernel grid=(1198,1,1) block=(256,1,1) lds=37120
; @launch kernel=k2_kernel grid=(256,1,1) block=(256,1,1) lds=81920
.amdgcn_target "amdgcn-amd-amdhsa--gfx950"
.text
.globl k1_kernel
.p2align 8
.type k1_kernel,@function
k1_kernel:
    s_cmp_ge_u32 s2, 1198
    s_cbranch_scc1 k1_end
    s_cmp_lt_u32 s2, 640
    s_cbranch_scc1 k1_ssm
    s_cmp_lt_u32 s2, 928
    s_cbranch_scc1 k1_gemm1
    s_branch k1_misc

k1_gemm1:
    s_load_dwordx2 s[4:5], s[0:1], 0
    s_load_dwordx2 s[6:7], s[0:1], 64
    s_load_dwordx2 s[8:9], s[0:1], 104
    v_lshrrev_b32 v7, 6, v0
    v_and_b32 v1, 63, v0
    v_and_b32 v2, 15, v1
    v_lshrrev_b32 v3, 4, v1
    v_lshrrev_b32 v4, 5, v1
    v_and_b32 v5, 31, v1
    v_readfirstlane_b32 s10, v7
    s_sub_u32 s11, s2, 640
    s_mul_i32 s12, s11, 3641
    s_lshr_b32 s12, s12, 16
    s_mul_i32 s13, s12, 18
    s_sub_u32 s11, s11, s13
    v_lshrrev_b32 v6, 2, v2
    v_lshl_add_u32 v6, v4, 3, v6
    v_mul_u32_u24 v6, 192, v6
    v_and_b32 v7, 1, v3
    v_lshl_add_u32 v6, v7, 5, v6
    v_and_b32 v7, 3, v2
    v_lshl_add_u32 v6, v7, 3, v6
    s_lshl_b32 s13, s10, 5
    v_add_u32 v15, s13, v5
    v_mul_u32_u24 v15, 80, v15
    v_lshl_add_u32 v15, v4, 4, v15
    v_lshrrev_b32 v7, 2, v0
    v_and_b32 v3, 3, v0
    v_lshlrev_b32 v3, 4, v3
    v_mul_u32_u24 v12, 1280, v7
    v_add_u32 v12, v12, v3
    v_mul_u32_u24 v13, 80, v7
    v_add_u32 v13, v13, v3
    v_lshlrev_b32 v14, 4, v0
    v_and_b32 v3, 127, v0
    v_lshlrev_b32 v2, 4, v3
    v_add_u32 v3, 256, v3

    v_mul_u32_u24 v7, 43691, v0
    v_lshrrev_b32 v7, 19, v7
    v_mul_u32_u24 v16, 12, v7
    v_sub_u32 v16, v0, v16
    v_mul_u32_u24 v7, 0xd80, v7
    v_lshl_add_u32 v1, v16, 4, v7

    v_mul_u32_u24 v7, 43691, v3
    v_lshrrev_b32 v7, 19, v7
    v_mul_u32_u24 v16, 12, v7
    v_sub_u32 v16, v3, v16
    v_mul_u32_u24 v7, 0xd80, v7
    v_lshl_add_u32 v3, v16, 4, v7

    s_mul_i32 s13, s12, 163840
    s_add_u32 s28, s13, 81920
    s_mul_i32 s14, s11, 192
    s_waitcnt lgkmcnt(0)

    s_mov_b32 s16, s4
    s_mov_b32 s17, s5
    s_mov_b32 s18, 2621440
    s_mov_b32 s19, 0x00020000
    s_mov_b32 s20, s6
    s_mov_b32 s21, s7
    s_mov_b32 s22, 2211840
    s_mov_b32 s23, 0x00020000
    s_mov_b32 s24, s8
    s_mov_b32 s25, s9
    s_mov_b32 s26, 7077888
    s_mov_b32 s27, 0x00020000
    v_mov_b32 v16, 0
    v_mov_b32 v17, 0
    v_mov_b32 v18, 0
    v_mov_b32 v19, 0
    v_mov_b32 v20, 0
    v_mov_b32 v21, 0
    v_mov_b32 v22, 0
    v_mov_b32 v23, 0
    v_mov_b32 v24, 0
    v_mov_b32 v25, 0
    v_mov_b32 v26, 0
    v_mov_b32 v27, 0
    v_mov_b32 v28, 0
    v_mov_b32 v29, 0
    v_mov_b32 v30, 0
    v_mov_b32 v31, 0
    v_mov_b32 v32, 0
    v_mov_b32 v33, 0
    v_mov_b32 v34, 0
    v_mov_b32 v35, 0
    v_mov_b32 v36, 0
    v_mov_b32 v37, 0
    v_mov_b32 v38, 0
    v_mov_b32 v39, 0
    v_mov_b32 v40, 0
    v_mov_b32 v41, 0
    v_mov_b32 v42, 0
    v_mov_b32 v43, 0
    v_mov_b32 v44, 0
    v_mov_b32 v45, 0
    v_mov_b32 v46, 0
    v_mov_b32 v47, 0
    v_mov_b32 v48, 0
    v_mov_b32 v49, 0
    v_mov_b32 v50, 0
    v_mov_b32 v51, 0
    v_mov_b32 v52, 0
    v_mov_b32 v53, 0
    v_mov_b32 v54, 0
    v_mov_b32 v55, 0
    v_mov_b32 v56, 0
    v_mov_b32 v57, 0
    v_mov_b32 v58, 0
    v_mov_b32 v59, 0
    v_mov_b32 v60, 0
    v_mov_b32 v61, 0
    v_mov_b32 v62, 0
    v_mov_b32 v63, 0
    buffer_load_dwordx4 v[64:67], v12, s[16:19], s13 offen offset:0
    buffer_load_dwordx4 v[68:71], v12, s[16:19], s28 offen offset:0
    s_add_u32 s15, s14, 0
    buffer_load_dwordx4 v[72:75], v1, s[20:23], s15 offen
    buffer_load_dwordx4 v[76:79], v3, s[20:23], s15 offen
    buffer_load_dwordx4 v[80:83], v12, s[16:19], s13 offen offset:64
    buffer_load_dwordx4 v[84:87], v12, s[16:19], s28 offen offset:64
    s_add_u32 s15, s14, 110592
    buffer_load_dwordx4 v[88:91], v1, s[20:23], s15 offen
    buffer_load_dwordx4 v[92:95], v3, s[20:23], s15 offen
    buffer_load_dwordx4 v[96:99], v12, s[16:19], s13 offen offset:128
    buffer_load_dwordx4 v[100:103], v12, s[16:19], s28 offen offset:128
    s_add_u32 s15, s14, 221184
    buffer_load_dwordx4 v[104:107], v1, s[20:23], s15 offen
    buffer_load_dwordx4 v[108:111], v3, s[20:23], s15 offen
    s_waitcnt vmcnt(8)
    ds_write_b128 v13, v[64:67] offset:0
    ds_write_b128 v13, v[68:71] offset:5120
    ds_write_b128 v14, v[72:75] offset:10240
    ds_write_b128 v2, v[76:79] offset:14336
    buffer_load_dwordx4 v[64:67], v12, s[16:19], s13 offen offset:192
    buffer_load_dwordx4 v[68:71], v12, s[16:19], s28 offen offset:192
    s_add_u32 s15, s14, 331776
    buffer_load_dwordx4 v[72:75], v1, s[20:23], s15 offen
    buffer_load_dwordx4 v[76:79], v3, s[20:23], s15 offen
    s_waitcnt lgkmcnt(0)
    s_barrier
    ds_read_b128 v[124:127], v15 offset:0
    ds_read_b64_tr_b16 v[112:113], v6 offset:10240
    ds_read_b64_tr_b16 v[114:115], v6 offset:11008
    ds_read_b64_tr_b16 v[116:117], v6 offset:10304
    ds_read_b64_tr_b16 v[118:119], v6 offset:11072
    ds_read_b64_tr_b16 v[120:121], v6 offset:10368
    ds_read_b64_tr_b16 v[122:123], v6 offset:11136
    ds_read_b128 v[8:11], v15 offset:32
    s_waitcnt lgkmcnt(5)
    v_mfma_f32_32x32x16_bf16 v[16:31], v[112:115], v[124:127], v[16:31]
    ds_read_b64_tr_b16 v[112:113], v6 offset:13312
    ds_read_b64_tr_b16 v[114:115], v6 offset:14080
    s_waitcnt lgkmcnt(5)
    v_mfma_f32_32x32x16_bf16 v[32:47], v[116:119], v[124:127], v[32:47]
    ds_read_b64_tr_b16 v[116:117], v6 offset:13376
    ds_read_b64_tr_b16 v[118:119], v6 offset:14144
    s_waitcnt lgkmcnt(5)
    v_mfma_f32_32x32x16_bf16 v[48:63], v[120:123], v[124:127], v[48:63]
    ds_read_b64_tr_b16 v[120:121], v6 offset:13440
    ds_read_b64_tr_b16 v[122:123], v6 offset:14208
    s_waitcnt lgkmcnt(4)
    v_mfma_f32_32x32x16_bf16 v[16:31], v[112:115], v[8:11], v[16:31]
    s_waitcnt lgkmcnt(2)
    v_mfma_f32_32x32x16_bf16 v[32:47], v[116:119], v[8:11], v[32:47]
    s_waitcnt lgkmcnt(0)
    v_mfma_f32_32x32x16_bf16 v[48:63], v[120:123], v[8:11], v[48:63]
    s_waitcnt vmcnt(8)
    ds_write_b128 v13, v[80:83] offset:16384
    ds_write_b128 v13, v[84:87] offset:21504
    ds_write_b128 v14, v[88:91] offset:26624
    ds_write_b128 v2, v[92:95] offset:30720
    buffer_load_dwordx4 v[80:83], v12, s[16:19], s13 offen offset:256
    buffer_load_dwordx4 v[84:87], v12, s[16:19], s28 offen offset:256
    s_add_u32 s15, s14, 442368
    buffer_load_dwordx4 v[88:91], v1, s[20:23], s15 offen
    buffer_load_dwordx4 v[92:95], v3, s[20:23], s15 offen
    s_waitcnt lgkmcnt(0)
    s_barrier
    ds_read_b128 v[124:127], v15 offset:16384
    ds_read_b64_tr_b16 v[112:113], v6 offset:26624
    ds_read_b64_tr_b16 v[114:115], v6 offset:27392
    ds_read_b64_tr_b16 v[116:117], v6 offset:26688
    ds_read_b64_tr_b16 v[118:119], v6 offset:27456
    ds_read_b64_tr_b16 v[120:121], v6 offset:26752
    ds_read_b64_tr_b16 v[122:123], v6 offset:27520
    ds_read_b128 v[8:11], v15 offset:16416
    s_waitcnt lgkmcnt(5)
    v_mfma_f32_32x32x16_bf16 v[16:31], v[112:115], v[124:127], v[16:31]
    ds_read_b64_tr_b16 v[112:113], v6 offset:29696
    ds_read_b64_tr_b16 v[114:115], v6 offset:30464
    s_waitcnt lgkmcnt(5)
    v_mfma_f32_32x32x16_bf16 v[32:47], v[116:119], v[124:127], v[32:47]
    ds_read_b64_tr_b16 v[116:117], v6 offset:29760
    ds_read_b64_tr_b16 v[118:119], v6 offset:30528
    s_waitcnt lgkmcnt(5)
    v_mfma_f32_32x32x16_bf16 v[48:63], v[120:123], v[124:127], v[48:63]
    ds_read_b64_tr_b16 v[120:121], v6 offset:29824
    ds_read_b64_tr_b16 v[122:123], v6 offset:30592
    s_waitcnt lgkmcnt(4)
    v_mfma_f32_32x32x16_bf16 v[16:31], v[112:115], v[8:11], v[16:31]
    s_waitcnt lgkmcnt(2)
    v_mfma_f32_32x32x16_bf16 v[32:47], v[116:119], v[8:11], v[32:47]
    s_waitcnt lgkmcnt(0)
    v_mfma_f32_32x32x16_bf16 v[48:63], v[120:123], v[8:11], v[48:63]
    s_waitcnt vmcnt(8)
    ds_write_b128 v13, v[96:99] offset:0
    ds_write_b128 v13, v[100:103] offset:5120
    ds_write_b128 v14, v[104:107] offset:10240
    ds_write_b128 v2, v[108:111] offset:14336
    buffer_load_dwordx4 v[96:99], v12, s[16:19], s13 offen offset:320
    buffer_load_dwordx4 v[100:103], v12, s[16:19], s28 offen offset:320
    s_add_u32 s15, s14, 552960
    buffer_load_dwordx4 v[104:107], v1, s[20:23], s15 offen
    buffer_load_dwordx4 v[108:111], v3, s[20:23], s15 offen
    s_waitcnt lgkmcnt(0)
    s_barrier
    ds_read_b128 v[124:127], v15 offset:0
    ds_read_b64_tr_b16 v[112:113], v6 offset:10240
    ds_read_b64_tr_b16 v[114:115], v6 offset:11008
    ds_read_b64_tr_b16 v[116:117], v6 offset:10304
    ds_read_b64_tr_b16 v[118:119], v6 offset:11072
    ds_read_b64_tr_b16 v[120:121], v6 offset:10368
    ds_read_b64_tr_b16 v[122:123], v6 offset:11136
    ds_read_b128 v[8:11], v15 offset:32
    s_waitcnt lgkmcnt(5)
    v_mfma_f32_32x32x16_bf16 v[16:31], v[112:115], v[124:127], v[16:31]
    ds_read_b64_tr_b16 v[112:113], v6 offset:13312
    ds_read_b64_tr_b16 v[114:115], v6 offset:14080
    s_waitcnt lgkmcnt(5)
    v_mfma_f32_32x32x16_bf16 v[32:47], v[116:119], v[124:127], v[32:47]
    ds_read_b64_tr_b16 v[116:117], v6 offset:13376
    ds_read_b64_tr_b16 v[118:119], v6 offset:14144
    s_waitcnt lgkmcnt(5)
    v_mfma_f32_32x32x16_bf16 v[48:63], v[120:123], v[124:127], v[48:63]
    ds_read_b64_tr_b16 v[120:121], v6 offset:13440
    ds_read_b64_tr_b16 v[122:123], v6 offset:14208
    s_waitcnt lgkmcnt(4)
    v_mfma_f32_32x32x16_bf16 v[16:31], v[112:115], v[8:11], v[16:31]
    s_waitcnt lgkmcnt(2)
    v_mfma_f32_32x32x16_bf16 v[32:47], v[116:119], v[8:11], v[32:47]
    s_waitcnt lgkmcnt(0)
    v_mfma_f32_32x32x16_bf16 v[48:63], v[120:123], v[8:11], v[48:63]
    s_waitcnt vmcnt(8)
    ds_write_b128 v13, v[64:67] offset:16384
    ds_write_b128 v13, v[68:71] offset:21504
    ds_write_b128 v14, v[72:75] offset:26624
    ds_write_b128 v2, v[76:79] offset:30720
    buffer_load_dwordx4 v[64:67], v12, s[16:19], s13 offen offset:384
    buffer_load_dwordx4 v[68:71], v12, s[16:19], s28 offen offset:384
    s_add_u32 s15, s14, 663552
    buffer_load_dwordx4 v[72:75], v1, s[20:23], s15 offen
    buffer_load_dwordx4 v[76:79], v3, s[20:23], s15 offen
    s_waitcnt lgkmcnt(0)
    s_barrier
    ds_read_b128 v[124:127], v15 offset:16384
    ds_read_b64_tr_b16 v[112:113], v6 offset:26624
    ds_read_b64_tr_b16 v[114:115], v6 offset:27392
    ds_read_b64_tr_b16 v[116:117], v6 offset:26688
    ds_read_b64_tr_b16 v[118:119], v6 offset:27456
    ds_read_b64_tr_b16 v[120:121], v6 offset:26752
    ds_read_b64_tr_b16 v[122:123], v6 offset:27520
    ds_read_b128 v[8:11], v15 offset:16416
    s_waitcnt lgkmcnt(5)
    v_mfma_f32_32x32x16_bf16 v[16:31], v[112:115], v[124:127], v[16:31]
    ds_read_b64_tr_b16 v[112:113], v6 offset:29696
    ds_read_b64_tr_b16 v[114:115], v6 offset:30464
    s_waitcnt lgkmcnt(5)
    v_mfma_f32_32x32x16_bf16 v[32:47], v[116:119], v[124:127], v[32:47]
    ds_read_b64_tr_b16 v[116:117], v6 offset:29760
    ds_read_b64_tr_b16 v[118:119], v6 offset:30528
    s_waitcnt lgkmcnt(5)
    v_mfma_f32_32x32x16_bf16 v[48:63], v[120:123], v[124:127], v[48:63]
    ds_read_b64_tr_b16 v[120:121], v6 offset:29824
    ds_read_b64_tr_b16 v[122:123], v6 offset:30592
    s_waitcnt lgkmcnt(4)
    v_mfma_f32_32x32x16_bf16 v[16:31], v[112:115], v[8:11], v[16:31]
    s_waitcnt lgkmcnt(2)
    v_mfma_f32_32x32x16_bf16 v[32:47], v[116:119], v[8:11], v[32:47]
    s_waitcnt lgkmcnt(0)
    v_mfma_f32_32x32x16_bf16 v[48:63], v[120:123], v[8:11], v[48:63]
    s_waitcnt vmcnt(8)
    ds_write_b128 v13, v[80:83] offset:0
    ds_write_b128 v13, v[84:87] offset:5120
    ds_write_b128 v14, v[88:91] offset:10240
    ds_write_b128 v2, v[92:95] offset:14336
    buffer_load_dwordx4 v[80:83], v12, s[16:19], s13 offen offset:448
    buffer_load_dwordx4 v[84:87], v12, s[16:19], s28 offen offset:448
    s_add_u32 s15, s14, 774144
    buffer_load_dwordx4 v[88:91], v1, s[20:23], s15 offen
    buffer_load_dwordx4 v[92:95], v3, s[20:23], s15 offen
    s_waitcnt lgkmcnt(0)
    s_barrier
    ds_read_b128 v[124:127], v15 offset:0
    ds_read_b64_tr_b16 v[112:113], v6 offset:10240
    ds_read_b64_tr_b16 v[114:115], v6 offset:11008
    ds_read_b64_tr_b16 v[116:117], v6 offset:10304
    ds_read_b64_tr_b16 v[118:119], v6 offset:11072
    ds_read_b64_tr_b16 v[120:121], v6 offset:10368
    ds_read_b64_tr_b16 v[122:123], v6 offset:11136
    ds_read_b128 v[8:11], v15 offset:32
    s_waitcnt lgkmcnt(5)
    v_mfma_f32_32x32x16_bf16 v[16:31], v[112:115], v[124:127], v[16:31]
    ds_read_b64_tr_b16 v[112:113], v6 offset:13312
    ds_read_b64_tr_b16 v[114:115], v6 offset:14080
    s_waitcnt lgkmcnt(5)
    v_mfma_f32_32x32x16_bf16 v[32:47], v[116:119], v[124:127], v[32:47]
    ds_read_b64_tr_b16 v[116:117], v6 offset:13376
    ds_read_b64_tr_b16 v[118:119], v6 offset:14144
    s_waitcnt lgkmcnt(5)
    v_mfma_f32_32x32x16_bf16 v[48:63], v[120:123], v[124:127], v[48:63]
    ds_read_b64_tr_b16 v[120:121], v6 offset:13440
    ds_read_b64_tr_b16 v[122:123], v6 offset:14208
    s_waitcnt lgkmcnt(4)
    v_mfma_f32_32x32x16_bf16 v[16:31], v[112:115], v[8:11], v[16:31]
    s_waitcnt lgkmcnt(2)
    v_mfma_f32_32x32x16_bf16 v[32:47], v[116:119], v[8:11], v[32:47]
    s_waitcnt lgkmcnt(0)
    v_mfma_f32_32x32x16_bf16 v[48:63], v[120:123], v[8:11], v[48:63]
    s_waitcnt vmcnt(8)
    ds_write_b128 v13, v[96:99] offset:16384
    ds_write_b128 v13, v[100:103] offset:21504
    ds_write_b128 v14, v[104:107] offset:26624
    ds_write_b128 v2, v[108:111] offset:30720
    buffer_load_dwordx4 v[96:99], v12, s[16:19], s13 offen offset:512
    buffer_load_dwordx4 v[100:103], v12, s[16:19], s28 offen offset:512
    s_add_u32 s15, s14, 884736
    buffer_load_dwordx4 v[104:107], v1, s[20:23], s15 offen
    buffer_load_dwordx4 v[108:111], v3, s[20:23], s15 offen
    s_waitcnt lgkmcnt(0)
    s_barrier
    ds_read_b128 v[124:127], v15 offset:16384
    ds_read_b64_tr_b16 v[112:113], v6 offset:26624
    ds_read_b64_tr_b16 v[114:115], v6 offset:27392
    ds_read_b64_tr_b16 v[116:117], v6 offset:26688
    ds_read_b64_tr_b16 v[118:119], v6 offset:27456
    ds_read_b64_tr_b16 v[120:121], v6 offset:26752
    ds_read_b64_tr_b16 v[122:123], v6 offset:27520
    ds_read_b128 v[8:11], v15 offset:16416
    s_waitcnt lgkmcnt(5)
    v_mfma_f32_32x32x16_bf16 v[16:31], v[112:115], v[124:127], v[16:31]
    ds_read_b64_tr_b16 v[112:113], v6 offset:29696
    ds_read_b64_tr_b16 v[114:115], v6 offset:30464
    s_waitcnt lgkmcnt(5)
    v_mfma_f32_32x32x16_bf16 v[32:47], v[116:119], v[124:127], v[32:47]
    ds_read_b64_tr_b16 v[116:117], v6 offset:29760
    ds_read_b64_tr_b16 v[118:119], v6 offset:30528
    s_waitcnt lgkmcnt(5)
    v_mfma_f32_32x32x16_bf16 v[48:63], v[120:123], v[124:127], v[48:63]
    ds_read_b64_tr_b16 v[120:121], v6 offset:29824
    ds_read_b64_tr_b16 v[122:123], v6 offset:30592
    s_waitcnt lgkmcnt(4)
    v_mfma_f32_32x32x16_bf16 v[16:31], v[112:115], v[8:11], v[16:31]
    s_waitcnt lgkmcnt(2)
    v_mfma_f32_32x32x16_bf16 v[32:47], v[116:119], v[8:11], v[32:47]
    s_waitcnt lgkmcnt(0)
    v_mfma_f32_32x32x16_bf16 v[48:63], v[120:123], v[8:11], v[48:63]
    s_waitcnt vmcnt(8)
    ds_write_b128 v13, v[64:67] offset:0
    ds_write_b128 v13, v[68:71] offset:5120
    ds_write_b128 v14, v[72:75] offset:10240
    ds_write_b128 v2, v[76:79] offset:14336
    buffer_load_dwordx4 v[64:67], v12, s[16:19], s13 offen offset:576
    buffer_load_dwordx4 v[68:71], v12, s[16:19], s28 offen offset:576
    s_add_u32 s15, s14, 995328
    buffer_load_dwordx4 v[72:75], v1, s[20:23], s15 offen
    buffer_load_dwordx4 v[76:79], v3, s[20:23], s15 offen
    s_waitcnt lgkmcnt(0)
    s_barrier
    ds_read_b128 v[124:127], v15 offset:0
    ds_read_b64_tr_b16 v[112:113], v6 offset:10240
    ds_read_b64_tr_b16 v[114:115], v6 offset:11008
    ds_read_b64_tr_b16 v[116:117], v6 offset:10304
    ds_read_b64_tr_b16 v[118:119], v6 offset:11072
    ds_read_b64_tr_b16 v[120:121], v6 offset:10368
    ds_read_b64_tr_b16 v[122:123], v6 offset:11136
    ds_read_b128 v[8:11], v15 offset:32
    s_waitcnt lgkmcnt(5)
    v_mfma_f32_32x32x16_bf16 v[16:31], v[112:115], v[124:127], v[16:31]
    ds_read_b64_tr_b16 v[112:113], v6 offset:13312
    ds_read_b64_tr_b16 v[114:115], v6 offset:14080
    s_waitcnt lgkmcnt(5)
    v_mfma_f32_32x32x16_bf16 v[32:47], v[116:119], v[124:127], v[32:47]
    ds_read_b64_tr_b16 v[116:117], v6 offset:13376
    ds_read_b64_tr_b16 v[118:119], v6 offset:14144
    s_waitcnt lgkmcnt(5)
    v_mfma_f32_32x32x16_bf16 v[48:63], v[120:123], v[124:127], v[48:63]
    ds_read_b64_tr_b16 v[120:121], v6 offset:13440
    ds_read_b64_tr_b16 v[122:123], v6 offset:14208
    s_waitcnt lgkmcnt(4)
    v_mfma_f32_32x32x16_bf16 v[16:31], v[112:115], v[8:11], v[16:31]
    s_waitcnt lgkmcnt(2)
    v_mfma_f32_32x32x16_bf16 v[32:47], v[116:119], v[8:11], v[32:47]
    s_waitcnt lgkmcnt(0)
    v_mfma_f32_32x32x16_bf16 v[48:63], v[120:123], v[8:11], v[48:63]
    s_waitcnt vmcnt(8)
    ds_write_b128 v13, v[80:83] offset:16384
    ds_write_b128 v13, v[84:87] offset:21504
    ds_write_b128 v14, v[88:91] offset:26624
    ds_write_b128 v2, v[92:95] offset:30720
    buffer_load_dwordx4 v[80:83], v12, s[16:19], s13 offen offset:640
    buffer_load_dwordx4 v[84:87], v12, s[16:19], s28 offen offset:640
    s_add_u32 s15, s14, 1105920
    buffer_load_dwordx4 v[88:91], v1, s[20:23], s15 offen
    buffer_load_dwordx4 v[92:95], v3, s[20:23], s15 offen
    s_waitcnt lgkmcnt(0)
    s_barrier
    ds_read_b128 v[124:127], v15 offset:16384
    ds_read_b64_tr_b16 v[112:113], v6 offset:26624
    ds_read_b64_tr_b16 v[114:115], v6 offset:27392
    ds_read_b64_tr_b16 v[116:117], v6 offset:26688
    ds_read_b64_tr_b16 v[118:119], v6 offset:27456
    ds_read_b64_tr_b16 v[120:121], v6 offset:26752
    ds_read_b64_tr_b16 v[122:123], v6 offset:27520
    ds_read_b128 v[8:11], v15 offset:16416
    s_waitcnt lgkmcnt(5)
    v_mfma_f32_32x32x16_bf16 v[16:31], v[112:115], v[124:127], v[16:31]
    ds_read_b64_tr_b16 v[112:113], v6 offset:29696
    ds_read_b64_tr_b16 v[114:115], v6 offset:30464
    s_waitcnt lgkmcnt(5)
    v_mfma_f32_32x32x16_bf16 v[32:47], v[116:119], v[124:127], v[32:47]
    ds_read_b64_tr_b16 v[116:117], v6 offset:29760
    ds_read_b64_tr_b16 v[118:119], v6 offset:30528
    s_waitcnt lgkmcnt(5)
    v_mfma_f32_32x32x16_bf16 v[48:63], v[120:123], v[124:127], v[48:63]
    ds_read_b64_tr_b16 v[120:121], v6 offset:29824
    ds_read_b64_tr_b16 v[122:123], v6 offset:30592
    s_waitcnt lgkmcnt(4)
    v_mfma_f32_32x32x16_bf16 v[16:31], v[112:115], v[8:11], v[16:31]
    s_waitcnt lgkmcnt(2)
    v_mfma_f32_32x32x16_bf16 v[32:47], v[116:119], v[8:11], v[32:47]
    s_waitcnt lgkmcnt(0)
    v_mfma_f32_32x32x16_bf16 v[48:63], v[120:123], v[8:11], v[48:63]
    s_waitcnt vmcnt(8)
    ds_write_b128 v13, v[96:99] offset:0
    ds_write_b128 v13, v[100:103] offset:5120
    ds_write_b128 v14, v[104:107] offset:10240
    ds_write_b128 v2, v[108:111] offset:14336
    buffer_load_dwordx4 v[96:99], v12, s[16:19], s13 offen offset:704
    buffer_load_dwordx4 v[100:103], v12, s[16:19], s28 offen offset:704
    s_add_u32 s15, s14, 1216512
    buffer_load_dwordx4 v[104:107], v1, s[20:23], s15 offen
    buffer_load_dwordx4 v[108:111], v3, s[20:23], s15 offen
    s_waitcnt lgkmcnt(0)
    s_barrier
    ds_read_b128 v[124:127], v15 offset:0
    ds_read_b64_tr_b16 v[112:113], v6 offset:10240
    ds_read_b64_tr_b16 v[114:115], v6 offset:11008
    ds_read_b64_tr_b16 v[116:117], v6 offset:10304
    ds_read_b64_tr_b16 v[118:119], v6 offset:11072
    ds_read_b64_tr_b16 v[120:121], v6 offset:10368
    ds_read_b64_tr_b16 v[122:123], v6 offset:11136
    ds_read_b128 v[8:11], v15 offset:32
    s_waitcnt lgkmcnt(5)
    v_mfma_f32_32x32x16_bf16 v[16:31], v[112:115], v[124:127], v[16:31]
    ds_read_b64_tr_b16 v[112:113], v6 offset:13312
    ds_read_b64_tr_b16 v[114:115], v6 offset:14080
    s_waitcnt lgkmcnt(5)
    v_mfma_f32_32x32x16_bf16 v[32:47], v[116:119], v[124:127], v[32:47]
    ds_read_b64_tr_b16 v[116:117], v6 offset:13376
    ds_read_b64_tr_b16 v[118:119], v6 offset:14144
    s_waitcnt lgkmcnt(5)
    v_mfma_f32_32x32x16_bf16 v[48:63], v[120:123], v[124:127], v[48:63]
    ds_read_b64_tr_b16 v[120:121], v6 offset:13440
    ds_read_b64_tr_b16 v[122:123], v6 offset:14208
    s_waitcnt lgkmcnt(4)
    v_mfma_f32_32x32x16_bf16 v[16:31], v[112:115], v[8:11], v[16:31]
    s_waitcnt lgkmcnt(2)
    v_mfma_f32_32x32x16_bf16 v[32:47], v[116:119], v[8:11], v[32:47]
    s_waitcnt lgkmcnt(0)
    v_mfma_f32_32x32x16_bf16 v[48:63], v[120:123], v[8:11], v[48:63]
    s_waitcnt vmcnt(8)
    ds_write_b128 v13, v[64:67] offset:16384
    ds_write_b128 v13, v[68:71] offset:21504
    ds_write_b128 v14, v[72:75] offset:26624
    ds_write_b128 v2, v[76:79] offset:30720
    buffer_load_dwordx4 v[64:67], v12, s[16:19], s13 offen offset:768
    buffer_load_dwordx4 v[68:71], v12, s[16:19], s28 offen offset:768
    s_add_u32 s15, s14, 1327104
    buffer_load_dwordx4 v[72:75], v1, s[20:23], s15 offen
    buffer_load_dwordx4 v[76:79], v3, s[20:23], s15 offen
    s_waitcnt lgkmcnt(0)
    s_barrier
    ds_read_b128 v[124:127], v15 offset:16384
    ds_read_b64_tr_b16 v[112:113], v6 offset:26624
    ds_read_b64_tr_b16 v[114:115], v6 offset:27392
    ds_read_b64_tr_b16 v[116:117], v6 offset:26688
    ds_read_b64_tr_b16 v[118:119], v6 offset:27456
    ds_read_b64_tr_b16 v[120:121], v6 offset:26752
    ds_read_b64_tr_b16 v[122:123], v6 offset:27520
    ds_read_b128 v[8:11], v15 offset:16416
    s_waitcnt lgkmcnt(5)
    v_mfma_f32_32x32x16_bf16 v[16:31], v[112:115], v[124:127], v[16:31]
    ds_read_b64_tr_b16 v[112:113], v6 offset:29696
    ds_read_b64_tr_b16 v[114:115], v6 offset:30464
    s_waitcnt lgkmcnt(5)
    v_mfma_f32_32x32x16_bf16 v[32:47], v[116:119], v[124:127], v[32:47]
    ds_read_b64_tr_b16 v[116:117], v6 offset:29760
    ds_read_b64_tr_b16 v[118:119], v6 offset:30528
    s_waitcnt lgkmcnt(5)
    v_mfma_f32_32x32x16_bf16 v[48:63], v[120:123], v[124:127], v[48:63]
    ds_read_b64_tr_b16 v[120:121], v6 offset:29824
    ds_read_b64_tr_b16 v[122:123], v6 offset:30592
    s_waitcnt lgkmcnt(4)
    v_mfma_f32_32x32x16_bf16 v[16:31], v[112:115], v[8:11], v[16:31]
    s_waitcnt lgkmcnt(2)
    v_mfma_f32_32x32x16_bf16 v[32:47], v[116:119], v[8:11], v[32:47]
    s_waitcnt lgkmcnt(0)
    v_mfma_f32_32x32x16_bf16 v[48:63], v[120:123], v[8:11], v[48:63]
    s_waitcnt vmcnt(8)
    ds_write_b128 v13, v[80:83] offset:0
    ds_write_b128 v13, v[84:87] offset:5120
    ds_write_b128 v14, v[88:91] offset:10240
    ds_write_b128 v2, v[92:95] offset:14336
    buffer_load_dwordx4 v[80:83], v12, s[16:19], s13 offen offset:832
    buffer_load_dwordx4 v[84:87], v12, s[16:19], s28 offen offset:832
    s_add_u32 s15, s14, 1437696
    buffer_load_dwordx4 v[88:91], v1, s[20:23], s15 offen
    buffer_load_dwordx4 v[92:95], v3, s[20:23], s15 offen
    s_waitcnt lgkmcnt(0)
    s_barrier
    ds_read_b128 v[124:127], v15 offset:0
    ds_read_b64_tr_b16 v[112:113], v6 offset:10240
    ds_read_b64_tr_b16 v[114:115], v6 offset:11008
    ds_read_b64_tr_b16 v[116:117], v6 offset:10304
    ds_read_b64_tr_b16 v[118:119], v6 offset:11072
    ds_read_b64_tr_b16 v[120:121], v6 offset:10368
    ds_read_b64_tr_b16 v[122:123], v6 offset:11136
    ds_read_b128 v[8:11], v15 offset:32
    s_waitcnt lgkmcnt(5)
    v_mfma_f32_32x32x16_bf16 v[16:31], v[112:115], v[124:127], v[16:31]
    ds_read_b64_tr_b16 v[112:113], v6 offset:13312
    ds_read_b64_tr_b16 v[114:115], v6 offset:14080
    s_waitcnt lgkmcnt(5)
    v_mfma_f32_32x32x16_bf16 v[32:47], v[116:119], v[124:127], v[32:47]
    ds_read_b64_tr_b16 v[116:117], v6 offset:13376
    ds_read_b64_tr_b16 v[118:119], v6 offset:14144
    s_waitcnt lgkmcnt(5)
    v_mfma_f32_32x32x16_bf16 v[48:63], v[120:123], v[124:127], v[48:63]
    ds_read_b64_tr_b16 v[120:121], v6 offset:13440
    ds_read_b64_tr_b16 v[122:123], v6 offset:14208
    s_waitcnt lgkmcnt(4)
    v_mfma_f32_32x32x16_bf16 v[16:31], v[112:115], v[8:11], v[16:31]
    s_waitcnt lgkmcnt(2)
    v_mfma_f32_32x32x16_bf16 v[32:47], v[116:119], v[8:11], v[32:47]
    s_waitcnt lgkmcnt(0)
    v_mfma_f32_32x32x16_bf16 v[48:63], v[120:123], v[8:11], v[48:63]
    s_waitcnt vmcnt(8)
    ds_write_b128 v13, v[96:99] offset:16384
    ds_write_b128 v13, v[100:103] offset:21504
    ds_write_b128 v14, v[104:107] offset:26624
    ds_write_b128 v2, v[108:111] offset:30720
    buffer_load_dwordx4 v[96:99], v12, s[16:19], s13 offen offset:896
    buffer_load_dwordx4 v[100:103], v12, s[16:19], s28 offen offset:896
    s_add_u32 s15, s14, 1548288
    buffer_load_dwordx4 v[104:107], v1, s[20:23], s15 offen
    buffer_load_dwordx4 v[108:111], v3, s[20:23], s15 offen
    s_waitcnt lgkmcnt(0)
    s_barrier
    ds_read_b128 v[124:127], v15 offset:16384
    ds_read_b64_tr_b16 v[112:113], v6 offset:26624
    ds_read_b64_tr_b16 v[114:115], v6 offset:27392
    ds_read_b64_tr_b16 v[116:117], v6 offset:26688
    ds_read_b64_tr_b16 v[118:119], v6 offset:27456
    ds_read_b64_tr_b16 v[120:121], v6 offset:26752
    ds_read_b64_tr_b16 v[122:123], v6 offset:27520
    ds_read_b128 v[8:11], v15 offset:16416
    s_waitcnt lgkmcnt(5)
    v_mfma_f32_32x32x16_bf16 v[16:31], v[112:115], v[124:127], v[16:31]
    ds_read_b64_tr_b16 v[112:113], v6 offset:29696
    ds_read_b64_tr_b16 v[114:115], v6 offset:30464
    s_waitcnt lgkmcnt(5)
    v_mfma_f32_32x32x16_bf16 v[32:47], v[116:119], v[124:127], v[32:47]
    ds_read_b64_tr_b16 v[116:117], v6 offset:29760
    ds_read_b64_tr_b16 v[118:119], v6 offset:30528
    s_waitcnt lgkmcnt(5)
    v_mfma_f32_32x32x16_bf16 v[48:63], v[120:123], v[124:127], v[48:63]
    ds_read_b64_tr_b16 v[120:121], v6 offset:29824
    ds_read_b64_tr_b16 v[122:123], v6 offset:30592
    s_waitcnt lgkmcnt(4)
    v_mfma_f32_32x32x16_bf16 v[16:31], v[112:115], v[8:11], v[16:31]
    s_waitcnt lgkmcnt(2)
    v_mfma_f32_32x32x16_bf16 v[32:47], v[116:119], v[8:11], v[32:47]
    s_waitcnt lgkmcnt(0)
    v_mfma_f32_32x32x16_bf16 v[48:63], v[120:123], v[8:11], v[48:63]
    s_waitcnt vmcnt(8)
    ds_write_b128 v13, v[64:67] offset:0
    ds_write_b128 v13, v[68:71] offset:5120
    ds_write_b128 v14, v[72:75] offset:10240
    ds_write_b128 v2, v[76:79] offset:14336
    buffer_load_dwordx4 v[64:67], v12, s[16:19], s13 offen offset:960
    buffer_load_dwordx4 v[68:71], v12, s[16:19], s28 offen offset:960
    s_add_u32 s15, s14, 1658880
    buffer_load_dwordx4 v[72:75], v1, s[20:23], s15 offen
    buffer_load_dwordx4 v[76:79], v3, s[20:23], s15 offen
    s_waitcnt lgkmcnt(0)
    s_barrier
    ds_read_b128 v[124:127], v15 offset:0
    ds_read_b64_tr_b16 v[112:113], v6 offset:10240
    ds_read_b64_tr_b16 v[114:115], v6 offset:11008
    ds_read_b64_tr_b16 v[116:117], v6 offset:10304
    ds_read_b64_tr_b16 v[118:119], v6 offset:11072
    ds_read_b64_tr_b16 v[120:121], v6 offset:10368
    ds_read_b64_tr_b16 v[122:123], v6 offset:11136
    ds_read_b128 v[8:11], v15 offset:32
    s_waitcnt lgkmcnt(5)
    v_mfma_f32_32x32x16_bf16 v[16:31], v[112:115], v[124:127], v[16:31]
    ds_read_b64_tr_b16 v[112:113], v6 offset:13312
    ds_read_b64_tr_b16 v[114:115], v6 offset:14080
    s_waitcnt lgkmcnt(5)
    v_mfma_f32_32x32x16_bf16 v[32:47], v[116:119], v[124:127], v[32:47]
    ds_read_b64_tr_b16 v[116:117], v6 offset:13376
    ds_read_b64_tr_b16 v[118:119], v6 offset:14144
    s_waitcnt lgkmcnt(5)
    v_mfma_f32_32x32x16_bf16 v[48:63], v[120:123], v[124:127], v[48:63]
    ds_read_b64_tr_b16 v[120:121], v6 offset:13440
    ds_read_b64_tr_b16 v[122:123], v6 offset:14208
    s_waitcnt lgkmcnt(4)
    v_mfma_f32_32x32x16_bf16 v[16:31], v[112:115], v[8:11], v[16:31]
    s_waitcnt lgkmcnt(2)
    v_mfma_f32_32x32x16_bf16 v[32:47], v[116:119], v[8:11], v[32:47]
    s_waitcnt lgkmcnt(0)
    v_mfma_f32_32x32x16_bf16 v[48:63], v[120:123], v[8:11], v[48:63]
    s_waitcnt vmcnt(8)
    ds_write_b128 v13, v[80:83] offset:16384
    ds_write_b128 v13, v[84:87] offset:21504
    ds_write_b128 v14, v[88:91] offset:26624
    ds_write_b128 v2, v[92:95] offset:30720
    buffer_load_dwordx4 v[80:83], v12, s[16:19], s13 offen offset:1024
    buffer_load_dwordx4 v[84:87], v12, s[16:19], s28 offen offset:1024
    s_add_u32 s15, s14, 1769472
    buffer_load_dwordx4 v[88:91], v1, s[20:23], s15 offen
    buffer_load_dwordx4 v[92:95], v3, s[20:23], s15 offen
    s_waitcnt lgkmcnt(0)
    s_barrier
    ds_read_b128 v[124:127], v15 offset:16384
    ds_read_b64_tr_b16 v[112:113], v6 offset:26624
    ds_read_b64_tr_b16 v[114:115], v6 offset:27392
    ds_read_b64_tr_b16 v[116:117], v6 offset:26688
    ds_read_b64_tr_b16 v[118:119], v6 offset:27456
    ds_read_b64_tr_b16 v[120:121], v6 offset:26752
    ds_read_b64_tr_b16 v[122:123], v6 offset:27520
    ds_read_b128 v[8:11], v15 offset:16416
    s_waitcnt lgkmcnt(5)
    v_mfma_f32_32x32x16_bf16 v[16:31], v[112:115], v[124:127], v[16:31]
    ds_read_b64_tr_b16 v[112:113], v6 offset:29696
    ds_read_b64_tr_b16 v[114:115], v6 offset:30464
    s_waitcnt lgkmcnt(5)
    v_mfma_f32_32x32x16_bf16 v[32:47], v[116:119], v[124:127], v[32:47]
    ds_read_b64_tr_b16 v[116:117], v6 offset:29760
    ds_read_b64_tr_b16 v[118:119], v6 offset:30528
    s_waitcnt lgkmcnt(5)
    v_mfma_f32_32x32x16_bf16 v[48:63], v[120:123], v[124:127], v[48:63]
    ds_read_b64_tr_b16 v[120:121], v6 offset:29824
    ds_read_b64_tr_b16 v[122:123], v6 offset:30592
    s_waitcnt lgkmcnt(4)
    v_mfma_f32_32x32x16_bf16 v[16:31], v[112:115], v[8:11], v[16:31]
    s_waitcnt lgkmcnt(2)
    v_mfma_f32_32x32x16_bf16 v[32:47], v[116:119], v[8:11], v[32:47]
    s_waitcnt lgkmcnt(0)
    v_mfma_f32_32x32x16_bf16 v[48:63], v[120:123], v[8:11], v[48:63]
    s_waitcnt vmcnt(8)
    ds_write_b128 v13, v[96:99] offset:0
    ds_write_b128 v13, v[100:103] offset:5120
    ds_write_b128 v14, v[104:107] offset:10240
    ds_write_b128 v2, v[108:111] offset:14336
    buffer_load_dwordx4 v[96:99], v12, s[16:19], s13 offen offset:1088
    buffer_load_dwordx4 v[100:103], v12, s[16:19], s28 offen offset:1088
    s_add_u32 s15, s14, 1880064
    buffer_load_dwordx4 v[104:107], v1, s[20:23], s15 offen
    buffer_load_dwordx4 v[108:111], v3, s[20:23], s15 offen
    s_waitcnt lgkmcnt(0)
    s_barrier
    ds_read_b128 v[124:127], v15 offset:0
    ds_read_b64_tr_b16 v[112:113], v6 offset:10240
    ds_read_b64_tr_b16 v[114:115], v6 offset:11008
    ds_read_b64_tr_b16 v[116:117], v6 offset:10304
    ds_read_b64_tr_b16 v[118:119], v6 offset:11072
    ds_read_b64_tr_b16 v[120:121], v6 offset:10368
    ds_read_b64_tr_b16 v[122:123], v6 offset:11136
    ds_read_b128 v[8:11], v15 offset:32
    s_waitcnt lgkmcnt(5)
    v_mfma_f32_32x32x16_bf16 v[16:31], v[112:115], v[124:127], v[16:31]
    ds_read_b64_tr_b16 v[112:113], v6 offset:13312
    ds_read_b64_tr_b16 v[114:115], v6 offset:14080
    s_waitcnt lgkmcnt(5)
    v_mfma_f32_32x32x16_bf16 v[32:47], v[116:119], v[124:127], v[32:47]
    ds_read_b64_tr_b16 v[116:117], v6 offset:13376
    ds_read_b64_tr_b16 v[118:119], v6 offset:14144
    s_waitcnt lgkmcnt(5)
    v_mfma_f32_32x32x16_bf16 v[48:63], v[120:123], v[124:127], v[48:63]
    ds_read_b64_tr_b16 v[120:121], v6 offset:13440
    ds_read_b64_tr_b16 v[122:123], v6 offset:14208
    s_waitcnt lgkmcnt(4)
    v_mfma_f32_32x32x16_bf16 v[16:31], v[112:115], v[8:11], v[16:31]
    s_waitcnt lgkmcnt(2)
    v_mfma_f32_32x32x16_bf16 v[32:47], v[116:119], v[8:11], v[32:47]
    s_waitcnt lgkmcnt(0)
    v_mfma_f32_32x32x16_bf16 v[48:63], v[120:123], v[8:11], v[48:63]
    s_waitcnt vmcnt(8)
    ds_write_b128 v13, v[64:67] offset:16384
    ds_write_b128 v13, v[68:71] offset:21504
    ds_write_b128 v14, v[72:75] offset:26624
    ds_write_b128 v2, v[76:79] offset:30720
    buffer_load_dwordx4 v[64:67], v12, s[16:19], s13 offen offset:1152
    buffer_load_dwordx4 v[68:71], v12, s[16:19], s28 offen offset:1152
    s_add_u32 s15, s14, 1990656
    buffer_load_dwordx4 v[72:75], v1, s[20:23], s15 offen
    buffer_load_dwordx4 v[76:79], v3, s[20:23], s15 offen
    s_waitcnt lgkmcnt(0)
    s_barrier
    ds_read_b128 v[124:127], v15 offset:16384
    ds_read_b64_tr_b16 v[112:113], v6 offset:26624
    ds_read_b64_tr_b16 v[114:115], v6 offset:27392
    ds_read_b64_tr_b16 v[116:117], v6 offset:26688
    ds_read_b64_tr_b16 v[118:119], v6 offset:27456
    ds_read_b64_tr_b16 v[120:121], v6 offset:26752
    ds_read_b64_tr_b16 v[122:123], v6 offset:27520
    ds_read_b128 v[8:11], v15 offset:16416
    s_waitcnt lgkmcnt(5)
    v_mfma_f32_32x32x16_bf16 v[16:31], v[112:115], v[124:127], v[16:31]
    ds_read_b64_tr_b16 v[112:113], v6 offset:29696
    ds_read_b64_tr_b16 v[114:115], v6 offset:30464
    s_waitcnt lgkmcnt(5)
    v_mfma_f32_32x32x16_bf16 v[32:47], v[116:119], v[124:127], v[32:47]
    ds_read_b64_tr_b16 v[116:117], v6 offset:29760
    ds_read_b64_tr_b16 v[118:119], v6 offset:30528
    s_waitcnt lgkmcnt(5)
    v_mfma_f32_32x32x16_bf16 v[48:63], v[120:123], v[124:127], v[48:63]
    ds_read_b64_tr_b16 v[120:121], v6 offset:29824
    ds_read_b64_tr_b16 v[122:123], v6 offset:30592
    s_waitcnt lgkmcnt(4)
    v_mfma_f32_32x32x16_bf16 v[16:31], v[112:115], v[8:11], v[16:31]
    s_waitcnt lgkmcnt(2)
    v_mfma_f32_32x32x16_bf16 v[32:47], v[116:119], v[8:11], v[32:47]
    s_waitcnt lgkmcnt(0)
    v_mfma_f32_32x32x16_bf16 v[48:63], v[120:123], v[8:11], v[48:63]
    s_waitcnt vmcnt(8)
    ds_write_b128 v13, v[80:83] offset:0
    ds_write_b128 v13, v[84:87] offset:5120
    ds_write_b128 v14, v[88:91] offset:10240
    ds_write_b128 v2, v[92:95] offset:14336
    buffer_load_dwordx4 v[80:83], v12, s[16:19], s13 offen offset:1216
    buffer_load_dwordx4 v[84:87], v12, s[16:19], s28 offen offset:1216
    s_add_u32 s15, s14, 2101248
    buffer_load_dwordx4 v[88:91], v1, s[20:23], s15 offen
    buffer_load_dwordx4 v[92:95], v3, s[20:23], s15 offen
    s_waitcnt lgkmcnt(0)
    s_barrier
    ds_read_b128 v[124:127], v15 offset:0
    ds_read_b64_tr_b16 v[112:113], v6 offset:10240
    ds_read_b64_tr_b16 v[114:115], v6 offset:11008
    ds_read_b64_tr_b16 v[116:117], v6 offset:10304
    ds_read_b64_tr_b16 v[118:119], v6 offset:11072
    ds_read_b64_tr_b16 v[120:121], v6 offset:10368
    ds_read_b64_tr_b16 v[122:123], v6 offset:11136
    ds_read_b128 v[8:11], v15 offset:32
    s_waitcnt lgkmcnt(5)
    v_mfma_f32_32x32x16_bf16 v[16:31], v[112:115], v[124:127], v[16:31]
    ds_read_b64_tr_b16 v[112:113], v6 offset:13312
    ds_read_b64_tr_b16 v[114:115], v6 offset:14080
    s_waitcnt lgkmcnt(5)
    v_mfma_f32_32x32x16_bf16 v[32:47], v[116:119], v[124:127], v[32:47]
    ds_read_b64_tr_b16 v[116:117], v6 offset:13376
    ds_read_b64_tr_b16 v[118:119], v6 offset:14144
    s_waitcnt lgkmcnt(5)
    v_mfma_f32_32x32x16_bf16 v[48:63], v[120:123], v[124:127], v[48:63]
    ds_read_b64_tr_b16 v[120:121], v6 offset:13440
    ds_read_b64_tr_b16 v[122:123], v6 offset:14208
    s_waitcnt lgkmcnt(4)
    v_mfma_f32_32x32x16_bf16 v[16:31], v[112:115], v[8:11], v[16:31]
    s_waitcnt lgkmcnt(2)
    v_mfma_f32_32x32x16_bf16 v[32:47], v[116:119], v[8:11], v[32:47]
    s_waitcnt lgkmcnt(0)
    v_mfma_f32_32x32x16_bf16 v[48:63], v[120:123], v[8:11], v[48:63]
    s_waitcnt vmcnt(8)
    ds_write_b128 v13, v[96:99] offset:16384
    ds_write_b128 v13, v[100:103] offset:21504
    ds_write_b128 v14, v[104:107] offset:26624
    ds_write_b128 v2, v[108:111] offset:30720
    s_waitcnt lgkmcnt(0)
    s_barrier
    ds_read_b128 v[124:127], v15 offset:16384
    ds_read_b64_tr_b16 v[112:113], v6 offset:26624
    ds_read_b64_tr_b16 v[114:115], v6 offset:27392
    ds_read_b64_tr_b16 v[116:117], v6 offset:26688
    ds_read_b64_tr_b16 v[118:119], v6 offset:27456
    ds_read_b64_tr_b16 v[120:121], v6 offset:26752
    ds_read_b64_tr_b16 v[122:123], v6 offset:27520
    ds_read_b128 v[8:11], v15 offset:16416
    s_waitcnt lgkmcnt(5)
    v_mfma_f32_32x32x16_bf16 v[16:31], v[112:115], v[124:127], v[16:31]
    ds_read_b64_tr_b16 v[112:113], v6 offset:29696
    ds_read_b64_tr_b16 v[114:115], v6 offset:30464
    s_waitcnt lgkmcnt(5)
    v_mfma_f32_32x32x16_bf16 v[32:47], v[116:119], v[124:127], v[32:47]
    ds_read_b64_tr_b16 v[116:117], v6 offset:29760
    ds_read_b64_tr_b16 v[118:119], v6 offset:30528
    s_waitcnt lgkmcnt(5)
    v_mfma_f32_32x32x16_bf16 v[48:63], v[120:123], v[124:127], v[48:63]
    ds_read_b64_tr_b16 v[120:121], v6 offset:29824
    ds_read_b64_tr_b16 v[122:123], v6 offset:30592
    s_waitcnt lgkmcnt(4)
    v_mfma_f32_32x32x16_bf16 v[16:31], v[112:115], v[8:11], v[16:31]
    s_waitcnt lgkmcnt(2)
    v_mfma_f32_32x32x16_bf16 v[32:47], v[116:119], v[8:11], v[32:47]
    s_waitcnt lgkmcnt(0)
    v_mfma_f32_32x32x16_bf16 v[48:63], v[120:123], v[8:11], v[48:63]
    s_waitcnt vmcnt(4)
    ds_write_b128 v13, v[64:67] offset:0
    ds_write_b128 v13, v[68:71] offset:5120
    ds_write_b128 v14, v[72:75] offset:10240
    ds_write_b128 v2, v[76:79] offset:14336
    s_waitcnt lgkmcnt(0)
    s_barrier
    ds_read_b128 v[124:127], v15 offset:0
    ds_read_b64_tr_b16 v[112:113], v6 offset:10240
    ds_read_b64_tr_b16 v[114:115], v6 offset:11008
    ds_read_b64_tr_b16 v[116:117], v6 offset:10304
    ds_read_b64_tr_b16 v[118:119], v6 offset:11072
    ds_read_b64_tr_b16 v[120:121], v6 offset:10368
    ds_read_b64_tr_b16 v[122:123], v6 offset:11136
    ds_read_b128 v[8:11], v15 offset:32
    s_waitcnt lgkmcnt(5)
    v_mfma_f32_32x32x16_bf16 v[16:31], v[112:115], v[124:127], v[16:31]
    ds_read_b64_tr_b16 v[112:113], v6 offset:13312
    ds_read_b64_tr_b16 v[114:115], v6 offset:14080
    s_waitcnt lgkmcnt(5)
    v_mfma_f32_32x32x16_bf16 v[32:47], v[116:119], v[124:127], v[32:47]
    ds_read_b64_tr_b16 v[116:117], v6 offset:13376
    ds_read_b64_tr_b16 v[118:119], v6 offset:14144
    s_waitcnt lgkmcnt(5)
    v_mfma_f32_32x32x16_bf16 v[48:63], v[120:123], v[124:127], v[48:63]
    ds_read_b64_tr_b16 v[120:121], v6 offset:13440
    ds_read_b64_tr_b16 v[122:123], v6 offset:14208
    s_waitcnt lgkmcnt(4)
    v_mfma_f32_32x32x16_bf16 v[16:31], v[112:115], v[8:11], v[16:31]
    s_waitcnt lgkmcnt(2)
    v_mfma_f32_32x32x16_bf16 v[32:47], v[116:119], v[8:11], v[32:47]
    s_waitcnt lgkmcnt(0)
    v_mfma_f32_32x32x16_bf16 v[48:63], v[120:123], v[8:11], v[48:63]
    s_waitcnt vmcnt(0)
    ds_write_b128 v13, v[80:83] offset:16384
    ds_write_b128 v13, v[84:87] offset:21504
    ds_write_b128 v14, v[88:91] offset:26624
    ds_write_b128 v2, v[92:95] offset:30720
    s_waitcnt lgkmcnt(0)
    s_barrier
    ds_read_b128 v[124:127], v15 offset:16384
    ds_read_b64_tr_b16 v[112:113], v6 offset:26624
    ds_read_b64_tr_b16 v[114:115], v6 offset:27392
    ds_read_b64_tr_b16 v[116:117], v6 offset:26688
    ds_read_b64_tr_b16 v[118:119], v6 offset:27456
    ds_read_b64_tr_b16 v[120:121], v6 offset:26752
    ds_read_b64_tr_b16 v[122:123], v6 offset:27520
    ds_read_b128 v[8:11], v15 offset:16416
    s_waitcnt lgkmcnt(5)
    v_mfma_f32_32x32x16_bf16 v[16:31], v[112:115], v[124:127], v[16:31]
    ds_read_b64_tr_b16 v[112:113], v6 offset:29696
    ds_read_b64_tr_b16 v[114:115], v6 offset:30464
    s_waitcnt lgkmcnt(5)
    v_mfma_f32_32x32x16_bf16 v[32:47], v[116:119], v[124:127], v[32:47]
    ds_read_b64_tr_b16 v[116:117], v6 offset:29760
    ds_read_b64_tr_b16 v[118:119], v6 offset:30528
    s_waitcnt lgkmcnt(5)
    v_mfma_f32_32x32x16_bf16 v[48:63], v[120:123], v[124:127], v[48:63]
    ds_read_b64_tr_b16 v[120:121], v6 offset:29824
    ds_read_b64_tr_b16 v[122:123], v6 offset:30592
    s_waitcnt lgkmcnt(4)
    v_mfma_f32_32x32x16_bf16 v[16:31], v[112:115], v[8:11], v[16:31]
    s_waitcnt lgkmcnt(2)
    v_mfma_f32_32x32x16_bf16 v[32:47], v[116:119], v[8:11], v[32:47]
    s_waitcnt lgkmcnt(0)
    v_mfma_f32_32x32x16_bf16 v[48:63], v[120:123], v[8:11], v[48:63]
    s_lshl_b32 s13, s12, 7
    s_lshl_b32 s15, s10, 5
    s_add_u32 s13, s13, s15
    v_add_u32 v7, s13, v5
    v_mul_u32_u24 v7, 0xd80, v7
    v_add_u32 v7, s14, v7
    v_lshl_add_u32 v7, v4, 3, v7
    s_mov_b32 s15, 0xbfb8aa3b
    s_nop 7
    s_nop 7

    v_cvt_pk_bf16_f32 v64, v16, v17
    v_cvt_pk_bf16_f32 v65, v18, v19
    v_lshlrev_b32 v66, 16, v64
    v_and_b32 v67, 0xffff0000, v64
    v_lshlrev_b32 v68, 16, v65
    v_and_b32 v69, 0xffff0000, v65
    v_mul_f32 v70, s15, v66
    v_mul_f32 v71, s15, v67
    v_mul_f32 v72, s15, v68
    v_mul_f32 v73, s15, v69
    v_exp_f32 v70, v70
    v_exp_f32 v71, v71
    v_exp_f32 v72, v72
    v_exp_f32 v73, v73
    v_add_f32 v70, 1.0, v70
    v_add_f32 v71, 1.0, v71
    v_add_f32 v72, 1.0, v72
    v_add_f32 v73, 1.0, v73
    v_rcp_f32 v70, v70
    v_rcp_f32 v71, v71
    v_rcp_f32 v72, v72
    v_rcp_f32 v73, v73
    v_mul_f32 v66, v66, v70
    v_mul_f32 v67, v67, v71
    v_mul_f32 v68, v68, v72
    v_mul_f32 v69, v69, v73
    v_cvt_pk_bf16_f32 v74, v66, v67
    v_cvt_pk_bf16_f32 v75, v68, v69
    buffer_store_dwordx2 v[74:75], v7, s[24:27], 0 offen offset:0

    v_cvt_pk_bf16_f32 v64, v20, v21
    v_cvt_pk_bf16_f32 v65, v22, v23
    v_lshlrev_b32 v66, 16, v64
    v_and_b32 v67, 0xffff0000, v64
    v_lshlrev_b32 v68, 16, v65
    v_and_b32 v69, 0xffff0000, v65
    v_mul_f32 v70, s15, v66
    v_mul_f32 v71, s15, v67
    v_mul_f32 v72, s15, v68
    v_mul_f32 v73, s15, v69
    v_exp_f32 v70, v70
    v_exp_f32 v71, v71
    v_exp_f32 v72, v72
    v_exp_f32 v73, v73
    v_add_f32 v70, 1.0, v70
    v_add_f32 v71, 1.0, v71
    v_add_f32 v72, 1.0, v72
    v_add_f32 v73, 1.0, v73
    v_rcp_f32 v70, v70
    v_rcp_f32 v71, v71
    v_rcp_f32 v72, v72
    v_rcp_f32 v73, v73
    v_mul_f32 v66, v66, v70
    v_mul_f32 v67, v67, v71
    v_mul_f32 v68, v68, v72
    v_mul_f32 v69, v69, v73
    v_cvt_pk_bf16_f32 v74, v66, v67
    v_cvt_pk_bf16_f32 v75, v68, v69
    buffer_store_dwordx2 v[74:75], v7, s[24:27], 0 offen offset:16

    v_cvt_pk_bf16_f32 v64, v24, v25
    v_cvt_pk_bf16_f32 v65, v26, v27
    v_lshlrev_b32 v66, 16, v64
    v_and_b32 v67, 0xffff0000, v64
    v_lshlrev_b32 v68, 16, v65
    v_and_b32 v69, 0xffff0000, v65
    v_mul_f32 v70, s15, v66
    v_mul_f32 v71, s15, v67
    v_mul_f32 v72, s15, v68
    v_mul_f32 v73, s15, v69
    v_exp_f32 v70, v70
    v_exp_f32 v71, v71
    v_exp_f32 v72, v72
    v_exp_f32 v73, v73
    v_add_f32 v70, 1.0, v70
    v_add_f32 v71, 1.0, v71
    v_add_f32 v72, 1.0, v72
    v_add_f32 v73, 1.0, v73
    v_rcp_f32 v70, v70
    v_rcp_f32 v71, v71
    v_rcp_f32 v72, v72
    v_rcp_f32 v73, v73
    v_mul_f32 v66, v66, v70
    v_mul_f32 v67, v67, v71
    v_mul_f32 v68, v68, v72
    v_mul_f32 v69, v69, v73
    v_cvt_pk_bf16_f32 v74, v66, v67
    v_cvt_pk_bf16_f32 v75, v68, v69
    buffer_store_dwordx2 v[74:75], v7, s[24:27], 0 offen offset:32

    v_cvt_pk_bf16_f32 v64, v28, v29
    v_cvt_pk_bf16_f32 v65, v30, v31
    v_lshlrev_b32 v66, 16, v64
    v_and_b32 v67, 0xffff0000, v64
    v_lshlrev_b32 v68, 16, v65
    v_and_b32 v69, 0xffff0000, v65
    v_mul_f32 v70, s15, v66
    v_mul_f32 v71, s15, v67
    v_mul_f32 v72, s15, v68
    v_mul_f32 v73, s15, v69
    v_exp_f32 v70, v70
    v_exp_f32 v71, v71
    v_exp_f32 v72, v72
    v_exp_f32 v73, v73
    v_add_f32 v70, 1.0, v70
    v_add_f32 v71, 1.0, v71
    v_add_f32 v72, 1.0, v72
    v_add_f32 v73, 1.0, v73
    v_rcp_f32 v70, v70
    v_rcp_f32 v71, v71
    v_rcp_f32 v72, v72
    v_rcp_f32 v73, v73
    v_mul_f32 v66, v66, v70
    v_mul_f32 v67, v67, v71
    v_mul_f32 v68, v68, v72
    v_mul_f32 v69, v69, v73
    v_cvt_pk_bf16_f32 v74, v66, v67
    v_cvt_pk_bf16_f32 v75, v68, v69
    buffer_store_dwordx2 v[74:75], v7, s[24:27], 0 offen offset:48

    v_cvt_pk_bf16_f32 v64, v32, v33
    v_cvt_pk_bf16_f32 v65, v34, v35
    v_lshlrev_b32 v66, 16, v64
    v_and_b32 v67, 0xffff0000, v64
    v_lshlrev_b32 v68, 16, v65
    v_and_b32 v69, 0xffff0000, v65
    v_mul_f32 v70, s15, v66
    v_mul_f32 v71, s15, v67
    v_mul_f32 v72, s15, v68
    v_mul_f32 v73, s15, v69
    v_exp_f32 v70, v70
    v_exp_f32 v71, v71
    v_exp_f32 v72, v72
    v_exp_f32 v73, v73
    v_add_f32 v70, 1.0, v70
    v_add_f32 v71, 1.0, v71
    v_add_f32 v72, 1.0, v72
    v_add_f32 v73, 1.0, v73
    v_rcp_f32 v70, v70
    v_rcp_f32 v71, v71
    v_rcp_f32 v72, v72
    v_rcp_f32 v73, v73
    v_mul_f32 v66, v66, v70
    v_mul_f32 v67, v67, v71
    v_mul_f32 v68, v68, v72
    v_mul_f32 v69, v69, v73
    v_cvt_pk_bf16_f32 v74, v66, v67
    v_cvt_pk_bf16_f32 v75, v68, v69
    buffer_store_dwordx2 v[74:75], v7, s[24:27], 0 offen offset:64

    v_cvt_pk_bf16_f32 v64, v36, v37
    v_cvt_pk_bf16_f32 v65, v38, v39
    v_lshlrev_b32 v66, 16, v64
    v_and_b32 v67, 0xffff0000, v64
    v_lshlrev_b32 v68, 16, v65
    v_and_b32 v69, 0xffff0000, v65
    v_mul_f32 v70, s15, v66
    v_mul_f32 v71, s15, v67
    v_mul_f32 v72, s15, v68
    v_mul_f32 v73, s15, v69
    v_exp_f32 v70, v70
    v_exp_f32 v71, v71
    v_exp_f32 v72, v72
    v_exp_f32 v73, v73
    v_add_f32 v70, 1.0, v70
    v_add_f32 v71, 1.0, v71
    v_add_f32 v72, 1.0, v72
    v_add_f32 v73, 1.0, v73
    v_rcp_f32 v70, v70
    v_rcp_f32 v71, v71
    v_rcp_f32 v72, v72
    v_rcp_f32 v73, v73
    v_mul_f32 v66, v66, v70
    v_mul_f32 v67, v67, v71
    v_mul_f32 v68, v68, v72
    v_mul_f32 v69, v69, v73
    v_cvt_pk_bf16_f32 v74, v66, v67
    v_cvt_pk_bf16_f32 v75, v68, v69
    buffer_store_dwordx2 v[74:75], v7, s[24:27], 0 offen offset:80

    v_cvt_pk_bf16_f32 v64, v40, v41
    v_cvt_pk_bf16_f32 v65, v42, v43
    v_lshlrev_b32 v66, 16, v64
    v_and_b32 v67, 0xffff0000, v64
    v_lshlrev_b32 v68, 16, v65
    v_and_b32 v69, 0xffff0000, v65
    v_mul_f32 v70, s15, v66
    v_mul_f32 v71, s15, v67
    v_mul_f32 v72, s15, v68
    v_mul_f32 v73, s15, v69
    v_exp_f32 v70, v70
    v_exp_f32 v71, v71
    v_exp_f32 v72, v72
    v_exp_f32 v73, v73
    v_add_f32 v70, 1.0, v70
    v_add_f32 v71, 1.0, v71
    v_add_f32 v72, 1.0, v72
    v_add_f32 v73, 1.0, v73
    v_rcp_f32 v70, v70
    v_rcp_f32 v71, v71
    v_rcp_f32 v72, v72
    v_rcp_f32 v73, v73
    v_mul_f32 v66, v66, v70
    v_mul_f32 v67, v67, v71
    v_mul_f32 v68, v68, v72
    v_mul_f32 v69, v69, v73
    v_cvt_pk_bf16_f32 v74, v66, v67
    v_cvt_pk_bf16_f32 v75, v68, v69
    buffer_store_dwordx2 v[74:75], v7, s[24:27], 0 offen offset:96

    v_cvt_pk_bf16_f32 v64, v44, v45
    v_cvt_pk_bf16_f32 v65, v46, v47
    v_lshlrev_b32 v66, 16, v64
    v_and_b32 v67, 0xffff0000, v64
    v_lshlrev_b32 v68, 16, v65
    v_and_b32 v69, 0xffff0000, v65
    v_mul_f32 v70, s15, v66
    v_mul_f32 v71, s15, v67
    v_mul_f32 v72, s15, v68
    v_mul_f32 v73, s15, v69
    v_exp_f32 v70, v70
    v_exp_f32 v71, v71
    v_exp_f32 v72, v72
    v_exp_f32 v73, v73
    v_add_f32 v70, 1.0, v70
    v_add_f32 v71, 1.0, v71
    v_add_f32 v72, 1.0, v72
    v_add_f32 v73, 1.0, v73
    v_rcp_f32 v70, v70
    v_rcp_f32 v71, v71
    v_rcp_f32 v72, v72
    v_rcp_f32 v73, v73
    v_mul_f32 v66, v66, v70
    v_mul_f32 v67, v67, v71
    v_mul_f32 v68, v68, v72
    v_mul_f32 v69, v69, v73
    v_cvt_pk_bf16_f32 v74, v66, v67
    v_cvt_pk_bf16_f32 v75, v68, v69
    buffer_store_dwordx2 v[74:75], v7, s[24:27], 0 offen offset:112

    v_cvt_pk_bf16_f32 v64, v48, v49
    v_cvt_pk_bf16_f32 v65, v50, v51
    v_lshlrev_b32 v66, 16, v64
    v_and_b32 v67, 0xffff0000, v64
    v_lshlrev_b32 v68, 16, v65
    v_and_b32 v69, 0xffff0000, v65
    v_mul_f32 v70, s15, v66
    v_mul_f32 v71, s15, v67
    v_mul_f32 v72, s15, v68
    v_mul_f32 v73, s15, v69
    v_exp_f32 v70, v70
    v_exp_f32 v71, v71
    v_exp_f32 v72, v72
    v_exp_f32 v73, v73
    v_add_f32 v70, 1.0, v70
    v_add_f32 v71, 1.0, v71
    v_add_f32 v72, 1.0, v72
    v_add_f32 v73, 1.0, v73
    v_rcp_f32 v70, v70
    v_rcp_f32 v71, v71
    v_rcp_f32 v72, v72
    v_rcp_f32 v73, v73
    v_mul_f32 v66, v66, v70
    v_mul_f32 v67, v67, v71
    v_mul_f32 v68, v68, v72
    v_mul_f32 v69, v69, v73
    v_cvt_pk_bf16_f32 v74, v66, v67
    v_cvt_pk_bf16_f32 v75, v68, v69
    buffer_store_dwordx2 v[74:75], v7, s[24:27], 0 offen offset:128

    v_cvt_pk_bf16_f32 v64, v52, v53
    v_cvt_pk_bf16_f32 v65, v54, v55
    v_lshlrev_b32 v66, 16, v64
    v_and_b32 v67, 0xffff0000, v64
    v_lshlrev_b32 v68, 16, v65
    v_and_b32 v69, 0xffff0000, v65
    v_mul_f32 v70, s15, v66
    v_mul_f32 v71, s15, v67
    v_mul_f32 v72, s15, v68
    v_mul_f32 v73, s15, v69
    v_exp_f32 v70, v70
    v_exp_f32 v71, v71
    v_exp_f32 v72, v72
    v_exp_f32 v73, v73
    v_add_f32 v70, 1.0, v70
    v_add_f32 v71, 1.0, v71
    v_add_f32 v72, 1.0, v72
    v_add_f32 v73, 1.0, v73
    v_rcp_f32 v70, v70
    v_rcp_f32 v71, v71
    v_rcp_f32 v72, v72
    v_rcp_f32 v73, v73
    v_mul_f32 v66, v66, v70
    v_mul_f32 v67, v67, v71
    v_mul_f32 v68, v68, v72
    v_mul_f32 v69, v69, v73
    v_cvt_pk_bf16_f32 v74, v66, v67
    v_cvt_pk_bf16_f32 v75, v68, v69
    buffer_store_dwordx2 v[74:75], v7, s[24:27], 0 offen offset:144

    v_cvt_pk_bf16_f32 v64, v56, v57
    v_cvt_pk_bf16_f32 v65, v58, v59
    v_lshlrev_b32 v66, 16, v64
    v_and_b32 v67, 0xffff0000, v64
    v_lshlrev_b32 v68, 16, v65
    v_and_b32 v69, 0xffff0000, v65
    v_mul_f32 v70, s15, v66
    v_mul_f32 v71, s15, v67
    v_mul_f32 v72, s15, v68
    v_mul_f32 v73, s15, v69
    v_exp_f32 v70, v70
    v_exp_f32 v71, v71
    v_exp_f32 v72, v72
    v_exp_f32 v73, v73
    v_add_f32 v70, 1.0, v70
    v_add_f32 v71, 1.0, v71
    v_add_f32 v72, 1.0, v72
    v_add_f32 v73, 1.0, v73
    v_rcp_f32 v70, v70
    v_rcp_f32 v71, v71
    v_rcp_f32 v72, v72
    v_rcp_f32 v73, v73
    v_mul_f32 v66, v66, v70
    v_mul_f32 v67, v67, v71
    v_mul_f32 v68, v68, v72
    v_mul_f32 v69, v69, v73
    v_cvt_pk_bf16_f32 v74, v66, v67
    v_cvt_pk_bf16_f32 v75, v68, v69
    buffer_store_dwordx2 v[74:75], v7, s[24:27], 0 offen offset:160

    v_cvt_pk_bf16_f32 v64, v60, v61
    v_cvt_pk_bf16_f32 v65, v62, v63
    v_lshlrev_b32 v66, 16, v64
    v_and_b32 v67, 0xffff0000, v64
    v_lshlrev_b32 v68, 16, v65
    v_and_b32 v69, 0xffff0000, v65
    v_mul_f32 v70, s15, v66
    v_mul_f32 v71, s15, v67
    v_mul_f32 v72, s15, v68
    v_mul_f32 v73, s15, v69
    v_exp_f32 v70, v70
    v_exp_f32 v71, v71
    v_exp_f32 v72, v72
    v_exp_f32 v73, v73
    v_add_f32 v70, 1.0, v70
    v_add_f32 v71, 1.0, v71
    v_add_f32 v72, 1.0, v72
    v_add_f32 v73, 1.0, v73
    v_rcp_f32 v70, v70
    v_rcp_f32 v71, v71
    v_rcp_f32 v72, v72
    v_rcp_f32 v73, v73
    v_mul_f32 v66, v66, v70
    v_mul_f32 v67, v67, v71
    v_mul_f32 v68, v68, v72
    v_mul_f32 v69, v69, v73
    v_cvt_pk_bf16_f32 v74, v66, v67
    v_cvt_pk_bf16_f32 v75, v68, v69
    buffer_store_dwordx2 v[74:75], v7, s[24:27], 0 offen offset:176

    s_waitcnt vmcnt(0)
    s_endpgm
k1_misc:
    s_load_dwordx2 s[4:5], s[0:1], 72
    s_load_dwordx2 s[6:7], s[0:1], 104
    s_load_dwordx2 s[8:9], s[0:1], 0
    s_load_dwordx2 s[10:11], s[0:1], 80
    v_lshrrev_b32 v7, 6, v0
    v_and_b32 v1, 63, v0
    v_readfirstlane_b32 s12, v7
    s_sub_u32 s13, s2, 928
    s_mul_i32 s14, s13, 6554
    s_lshr_b32 s14, s14, 16
    s_mul_i32 s15, s14, 10
    s_sub_u32 s15, s13, s15
    s_waitcnt lgkmcnt(0)

    s_mov_b32 s16, s4
    s_mov_b32 s17, s5
    s_mov_b32 s18, 2211840
    s_mov_b32 s19, 0x00020000
    s_add_u32 s20, s6, 10485760
    s_addc_u32 s21, s7, 0
    s_mov_b32 s22, 2211840
    s_mov_b32 s23, 0x00020000
    s_mov_b32 s24, s8
    s_mov_b32 s25, s9
    s_mov_b32 s26, 2621440
    s_mov_b32 s27, 0x00020000
    s_mov_b32 s28, s10
    s_mov_b32 s29, s11
    s_mov_b32 s30, 1280
    s_mov_b32 s31, 0x00020000
    s_add_u32 s32, s6, 13631488
    s_addc_u32 s33, s7, 0
    s_mov_b32 s34, 8192
    s_mov_b32 s35, 0x00020000
    v_lshrrev_b32 v2, 3, v0
    v_and_b32 v3, 7, v0
    v_mul_u32_u24 v4, 1280, v2
    v_lshl_add_u32 v4, v3, 4, v4
    s_mul_i32 s36, s14, 81920
    s_lshl_b32 s37, s15, 7
    s_add_u32 s36, s36, s37
    s_add_u32 s37, s36, 40960
    buffer_load_dwordx4 v[8:11], v4, s[16:19], s36 offen
    buffer_load_dwordx4 v[12:15], v4, s[16:19], s37 offen
    v_mul_u32_u24 v5, 144, v2
    v_lshl_add_u32 v5, v3, 4, v5
    s_waitcnt vmcnt(0)
    ds_write_b128 v5, v[8:11]
    ds_write_b128 v5, v[12:15] offset:4608
    s_waitcnt lgkmcnt(0)
    s_barrier
    v_and_b32 v2, 15, v1
    v_lshrrev_b32 v3, 4, v1
    v_lshrrev_b32 v6, 2, v2
    v_lshl_add_u32 v6, v3, 4, v6
    v_mul_u32_u24 v6, 144, v6
    v_and_b32 v7, 3, v2
    v_lshl_add_u32 v6, v7, 3, v6
    s_lshl_b32 s38, s12, 5
    v_add_u32 v6, s38, v6
    ds_read_b64_tr_b16 v[8:9], v6
    ds_read_b64_tr_b16 v[10:11], v6 offset:576
    ds_read_b64_tr_b16 v[12:13], v6 offset:1152
    ds_read_b64_tr_b16 v[14:15], v6 offset:1728
    s_lshl_b32 s38, s15, 6
    s_lshl_b32 s39, s12, 4
    s_add_u32 s38, s38, s39
    v_add_u32 v7, s38, v2
    v_mul_u32_u24 v7, 0xd80, v7
    v_lshl_add_u32 v7, v3, 5, v7
    s_lshl_b32 s38, s14, 7
    s_waitcnt lgkmcnt(0)
    buffer_store_dwordx4 v[8:11], v7, s[20:23], s38 offen
    buffer_store_dwordx4 v[12:15], v7, s[20:23], s38 offen offset:16
    s_cmp_ge_u32 s13, 256
    s_cbranch_scc1 k1_misc_done
    s_lshl_b32 s38, s13, 3
    s_lshl_b32 s39, s12, 1
    s_add_u32 s38, s38, s39
    s_mul_i32 s39, s38, 1280
    v_lshlrev_b32 v2, 2, v1

    buffer_load_dword v16, v2, s[28:31], 0 offen offset:0
    buffer_load_dword v17, v2, s[28:31], 0 offen offset:256
    buffer_load_dword v18, v2, s[28:31], 0 offen offset:512
    buffer_load_dword v19, v2, s[28:31], 0 offen offset:768
    buffer_load_dword v20, v2, s[28:31], 0 offen offset:1024
    buffer_load_dword v24, v2, s[24:27], s39 offen offset:0
    buffer_load_dword v25, v2, s[24:27], s39 offen offset:256
    buffer_load_dword v26, v2, s[24:27], s39 offen offset:512
    buffer_load_dword v27, v2, s[24:27], s39 offen offset:768
    buffer_load_dword v28, v2, s[24:27], s39 offen offset:1024
    buffer_load_dword v29, v2, s[24:27], s39 offen offset:1280
    buffer_load_dword v30, v2, s[24:27], s39 offen offset:1536
    buffer_load_dword v31, v2, s[24:27], s39 offen offset:1792
    buffer_load_dword v32, v2, s[24:27], s39 offen offset:2048
    buffer_load_dword v33, v2, s[24:27], s39 offen offset:2304
    s_waitcnt vmcnt(0)
    v_lshlrev_b32 v40, 16, v16
    v_and_b32 v41, 0xffff0000, v16
    v_lshlrev_b32 v42, 16, v17
    v_and_b32 v43, 0xffff0000, v17
    v_lshlrev_b32 v44, 16, v18
    v_and_b32 v45, 0xffff0000, v18
    v_lshlrev_b32 v46, 16, v19
    v_and_b32 v47, 0xffff0000, v19
    v_lshlrev_b32 v48, 16, v20
    v_and_b32 v49, 0xffff0000, v20
    v_mov_b32 v60, 0
    v_lshlrev_b32 v52, 16, v24
    v_and_b32 v53, 0xffff0000, v24
    v_mul_f32 v52, v52, v40
    v_mul_f32 v53, v53, v41
    v_cvt_pk_bf16_f32 v54, v52, v53
    v_lshlrev_b32 v52, 16, v54
    v_and_b32 v53, 0xffff0000, v54
    v_add_f32 v60, v60, v52
    v_add_f32 v60, v60, v53

    v_lshlrev_b32 v52, 16, v25
    v_and_b32 v53, 0xffff0000, v25
    v_mul_f32 v52, v52, v42
    v_mul_f32 v53, v53, v43
    v_cvt_pk_bf16_f32 v54, v52, v53
    v_lshlrev_b32 v52, 16, v54
    v_and_b32 v53, 0xffff0000, v54
    v_add_f32 v60, v60, v52
    v_add_f32 v60, v60, v53

    v_lshlrev_b32 v52, 16, v26
    v_and_b32 v53, 0xffff0000, v26
    v_mul_f32 v52, v52, v44
    v_mul_f32 v53, v53, v45
    v_cvt_pk_bf16_f32 v54, v52, v53
    v_lshlrev_b32 v52, 16, v54
    v_and_b32 v53, 0xffff0000, v54
    v_add_f32 v60, v60, v52
    v_add_f32 v60, v60, v53

    v_lshlrev_b32 v52, 16, v27
    v_and_b32 v53, 0xffff0000, v27
    v_mul_f32 v52, v52, v46
    v_mul_f32 v53, v53, v47
    v_cvt_pk_bf16_f32 v54, v52, v53
    v_lshlrev_b32 v52, 16, v54
    v_and_b32 v53, 0xffff0000, v54
    v_add_f32 v60, v60, v52
    v_add_f32 v60, v60, v53

    v_lshlrev_b32 v52, 16, v28
    v_and_b32 v53, 0xffff0000, v28
    v_mul_f32 v52, v52, v48
    v_mul_f32 v53, v53, v49
    v_cvt_pk_bf16_f32 v54, v52, v53
    v_lshlrev_b32 v52, 16, v54
    v_and_b32 v53, 0xffff0000, v54
    v_add_f32 v60, v60, v52
    v_add_f32 v60, v60, v53

    v_mov_b32 v61, 0
    v_lshlrev_b32 v52, 16, v29
    v_and_b32 v53, 0xffff0000, v29
    v_mul_f32 v52, v52, v40
    v_mul_f32 v53, v53, v41
    v_cvt_pk_bf16_f32 v54, v52, v53
    v_lshlrev_b32 v52, 16, v54
    v_and_b32 v53, 0xffff0000, v54
    v_add_f32 v61, v61, v52
    v_add_f32 v61, v61, v53

    v_lshlrev_b32 v52, 16, v30
    v_and_b32 v53, 0xffff0000, v30
    v_mul_f32 v52, v52, v42
    v_mul_f32 v53, v53, v43
    v_cvt_pk_bf16_f32 v54, v52, v53
    v_lshlrev_b32 v52, 16, v54
    v_and_b32 v53, 0xffff0000, v54
    v_add_f32 v61, v61, v52
    v_add_f32 v61, v61, v53

    v_lshlrev_b32 v52, 16, v31
    v_and_b32 v53, 0xffff0000, v31
    v_mul_f32 v52, v52, v44
    v_mul_f32 v53, v53, v45
    v_cvt_pk_bf16_f32 v54, v52, v53
    v_lshlrev_b32 v52, 16, v54
    v_and_b32 v53, 0xffff0000, v54
    v_add_f32 v61, v61, v52
    v_add_f32 v61, v61, v53

    v_lshlrev_b32 v52, 16, v32
    v_and_b32 v53, 0xffff0000, v32
    v_mul_f32 v52, v52, v46
    v_mul_f32 v53, v53, v47
    v_cvt_pk_bf16_f32 v54, v52, v53
    v_lshlrev_b32 v52, 16, v54
    v_and_b32 v53, 0xffff0000, v54
    v_add_f32 v61, v61, v52
    v_add_f32 v61, v61, v53

    v_lshlrev_b32 v52, 16, v33
    v_and_b32 v53, 0xffff0000, v33
    v_mul_f32 v52, v52, v48
    v_mul_f32 v53, v53, v49
    v_cvt_pk_bf16_f32 v54, v52, v53
    v_lshlrev_b32 v52, 16, v54
    v_and_b32 v53, 0xffff0000, v54
    v_add_f32 v61, v61, v52
    v_add_f32 v61, v61, v53

    v_xor_b32 v3, 1, v1
    v_lshlrev_b32 v3, 2, v3
    ds_bpermute_b32 v62, v3, v60
    ds_bpermute_b32 v63, v3, v61
    s_waitcnt lgkmcnt(0)
    v_add_f32 v60, v60, v62
    v_add_f32 v61, v61, v63

    v_xor_b32 v3, 2, v1
    v_lshlrev_b32 v3, 2, v3
    ds_bpermute_b32 v62, v3, v60
    ds_bpermute_b32 v63, v3, v61
    s_waitcnt lgkmcnt(0)
    v_add_f32 v60, v60, v62
    v_add_f32 v61, v61, v63

    v_xor_b32 v3, 4, v1
    v_lshlrev_b32 v3, 2, v3
    ds_bpermute_b32 v62, v3, v60
    ds_bpermute_b32 v63, v3, v61
    s_waitcnt lgkmcnt(0)
    v_add_f32 v60, v60, v62
    v_add_f32 v61, v61, v63

    v_xor_b32 v3, 8, v1
    v_lshlrev_b32 v3, 2, v3
    ds_bpermute_b32 v62, v3, v60
    ds_bpermute_b32 v63, v3, v61
    s_waitcnt lgkmcnt(0)
    v_add_f32 v60, v60, v62
    v_add_f32 v61, v61, v63

    v_xor_b32 v3, 16, v1
    v_lshlrev_b32 v3, 2, v3
    ds_bpermute_b32 v62, v3, v60
    ds_bpermute_b32 v63, v3, v61
    s_waitcnt lgkmcnt(0)
    v_add_f32 v60, v60, v62
    v_add_f32 v61, v61, v63

    v_xor_b32 v3, 32, v1
    v_lshlrev_b32 v3, 2, v3
    ds_bpermute_b32 v62, v3, v60
    ds_bpermute_b32 v63, v3, v61
    s_waitcnt lgkmcnt(0)
    v_add_f32 v60, v60, v62
    v_add_f32 v61, v61, v63

    v_cvt_pk_bf16_f32 v62, v60, v61
    v_lshlrev_b32 v60, 16, v62
    v_and_b32 v61, 0xffff0000, v62
    s_mov_b32 s40, 0xbfb8aa3b
    v_mul_f32 v60, s40, v60
    v_mul_f32 v61, s40, v61
    v_exp_f32 v60, v60
    v_exp_f32 v61, v61
    s_nop 0
    v_add_f32 v60, 1.0, v60
    v_add_f32 v61, 1.0, v61
    v_rcp_f32 v60, v60
    v_rcp_f32 v61, v61
    s_nop 0
    v_cvt_pk_bf16_f32 v62, v60, v61
    v_lshlrev_b32 v60, 16, v62
    v_and_b32 v61, 0xffff0000, v62
    s_lshl_b32 s39, s38, 2
    v_mov_b32 v3, s39
    v_cmp_eq_u32 vcc, 0, v1
    s_and_saveexec_b64 s[42:43], vcc
    buffer_store_dwordx2 v[60:61], v3, s[32:35], 0 offen
    s_mov_b64 exec, s[42:43]

k1_misc_done:
    s_waitcnt vmcnt(0)
    s_endpgm
k1_ssm:
    s_load_dwordx2 s[4:5], s[0:1], 0
    s_load_dwordx2 s[6:7], s[0:1], 8
    s_load_dwordx2 s[8:9], s[0:1], 16
    s_load_dwordx2 s[10:11], s[0:1], 24
    s_load_dwordx2 s[12:13], s[0:1], 32
    s_load_dwordx2 s[14:15], s[0:1], 40
    s_load_dwordx2 s[50:51], s[0:1], 48
    s_load_dwordx2 s[52:53], s[0:1], 104
    v_lshrrev_b32 v7, 6, v0
    v_and_b32 v1, 63, v0
    v_and_b32 v2, 15, v1
    v_lshrrev_b32 v3, 4, v1
    v_lshrrev_b32 v4, 5, v1
    v_and_b32 v5, 31, v1
    v_readfirstlane_b32 s3, v7
    s_waitcnt lgkmcnt(0)

    s_mov_b32 s16, s4
    s_mov_b32 s17, s5
    s_mov_b32 s18, 2621440
    s_mov_b32 s19, 0x00020000
    s_mov_b32 s20, s6
    s_mov_b32 s21, s7
    s_mov_b32 s22, 163840
    s_mov_b32 s23, 0x00020000
    s_mov_b32 s24, s8
    s_mov_b32 s25, s9
    s_mov_b32 s26, 163840
    s_mov_b32 s27, 0x00020000
    s_mov_b32 s28, s10
    s_mov_b32 s29, s11
    s_mov_b32 s30, 163840
    s_mov_b32 s31, 0x00020000
    s_mov_b32 s32, s12
    s_mov_b32 s33, s13
    s_mov_b32 s34, 163840
    s_mov_b32 s35, 0x00020000
    s_mov_b32 s36, s14
    s_mov_b32 s37, s15
    s_mov_b32 s38, 1280
    s_mov_b32 s39, 0x00020000
    s_mov_b32 s40, s50
    s_mov_b32 s41, s51
    s_mov_b32 s42, 1280
    s_mov_b32 s43, 0x00020000
    s_add_u32 s44, s52, 7340032
    s_addc_u32 s45, s53, 0
    s_mov_b32 s46, 2621440
    s_mov_b32 s47, 0x00020000
    s_lshl_b32 s54, s2, 1
    s_lshl_b32 s55, s2, 8
    s_lshl_b32 s56, s3, 6
    s_add_u32 s55, s55, s56
    v_lshlrev_b32 v7, 3, v3

    buffer_load_dwordx2 v[16:17], v7, s[20:23], s55 offen offset:0
    buffer_load_dwordx2 v[18:19], v7, s[20:23], s55 offen offset:32
    buffer_load_dwordx2 v[20:21], v7, s[24:27], s55 offen offset:0
    buffer_load_dwordx2 v[22:23], v7, s[24:27], s55 offen offset:32
    buffer_load_dwordx2 v[24:25], v7, s[28:31], s55 offen offset:0
    buffer_load_dwordx2 v[26:27], v7, s[28:31], s55 offen offset:32
    buffer_load_dwordx2 v[28:29], v7, s[32:35], s55 offen offset:0
    buffer_load_dwordx2 v[30:31], v7, s[32:35], s55 offen offset:32
    v_mov_b32 v7, s54
    buffer_load_ushort v14, v7, s[36:39], 0 offen
    buffer_load_ushort v15, v7, s[40:43], 0 offen
    v_mul_u32_u24 v6, 1280, v0

    s_add_u32 s55, s54, 0
    buffer_load_ushort v114, v6, s[16:19], s55 offen
    s_add_u32 s55, s54, 327680
    buffer_load_ushort v115, v6, s[16:19], s55 offen
    s_add_u32 s55, s54, 655360
    buffer_load_ushort v116, v6, s[16:19], s55 offen
    s_add_u32 s55, s54, 983040
    buffer_load_ushort v117, v6, s[16:19], s55 offen
    s_add_u32 s55, s54, 1310720
    buffer_load_ushort v118, v6, s[16:19], s55 offen
    s_add_u32 s55, s54, 1638400
    buffer_load_ushort v119, v6, s[16:19], s55 offen
    s_add_u32 s55, s54, 1966080
    buffer_load_ushort v120, v6, s[16:19], s55 offen
    s_add_u32 s55, s54, 2293760
    buffer_load_ushort v121, v6, s[16:19], s55 offen
    v_mov_b32 v92, 0
    v_mov_b32 v93, 0
    v_mov_b32 v94, 0
    v_mov_b32 v95, 0
    v_lshlrev_b32 v7, 4, v0
    ds_write_b128 v7, v[92:95] offset:4352
    ds_write_b128 v7, v[92:95] offset:12032
    v_cmp_gt_u32 vcc, 4, v0
    s_and_saveexec_b64 s[58:59], vcc
    ds_write_b128 v7, v[92:95] offset:4096
    s_mov_b64 exec, s[58:59]
    s_mov_b32 s60, 0x3fb8aa3b
    s_mov_b32 s61, 0xbfb8aa3b
    s_mov_b32 s62, 0x3e22f983
    s_mov_b32 s63, 0x7fff
    s_mov_b32 s64, 384
    s_mov_b32 s65, 256
    s_waitcnt vmcnt(8)

    v_lshlrev_b32 v14, 16, v14
    v_mul_f32 v14, s60, v14
    v_exp_f32 v14, v14
    v_lshlrev_b32 v15, 16, v15
    v_cvt_pk_bf16_f32 v14, v14, v14
    v_lshlrev_b32 v14, 16, v14

    v_lshlrev_b32 v92, 16, v16
    v_mul_f32 v92, s60, v92
    v_exp_f32 v92, v92

    v_lshlrev_b32 v93, 16, v20
    v_lshlrev_b32 v94, 16, v24
    v_lshlrev_b32 v95, 16, v28
    v_cvt_pk_bf16_f32 v92, v92, v92
    v_lshlrev_b32 v92, 16, v92
    v_mul_f32 v92, v92, v14
    v_mul_f32 v32, s61, v92
    v_mul_f32 v93, v93, v14
    v_mul_f32 v40, s62, v93
    v_mul_f32 v94, v94, v14
    v_add_f32 v48, v94, v94
    v_mul_f32 v95, v95, v14
    v_add_f32 v56, v95, v95

    v_and_b32 v92, 0xffff0000, v16
    v_mul_f32 v92, s60, v92
    v_exp_f32 v92, v92

    v_and_b32 v93, 0xffff0000, v20
    v_and_b32 v94, 0xffff0000, v24
    v_and_b32 v95, 0xffff0000, v28
    v_cvt_pk_bf16_f32 v92, v92, v92
    v_lshlrev_b32 v92, 16, v92
    v_mul_f32 v92, v92, v14
    v_mul_f32 v33, s61, v92
    v_mul_f32 v93, v93, v14
    v_mul_f32 v41, s62, v93
    v_mul_f32 v94, v94, v14
    v_add_f32 v49, v94, v94
    v_mul_f32 v95, v95, v14
    v_add_f32 v57, v95, v95

    v_lshlrev_b32 v92, 16, v17
    v_mul_f32 v92, s60, v92
    v_exp_f32 v92, v92

    v_lshlrev_b32 v93, 16, v21
    v_lshlrev_b32 v94, 16, v25
    v_lshlrev_b32 v95, 16, v29
    v_cvt_pk_bf16_f32 v92, v92, v92
    v_lshlrev_b32 v92, 16, v92
    v_mul_f32 v92, v92, v14
    v_mul_f32 v34, s61, v92
    v_mul_f32 v93, v93, v14
    v_mul_f32 v42, s62, v93
    v_mul_f32 v94, v94, v14
    v_add_f32 v50, v94, v94
    v_mul_f32 v95, v95, v14
    v_add_f32 v58, v95, v95

    v_and_b32 v92, 0xffff0000, v17
    v_mul_f32 v92, s60, v92
    v_exp_f32 v92, v92

    v_and_b32 v93, 0xffff0000, v21
    v_and_b32 v94, 0xffff0000, v25
    v_and_b32 v95, 0xffff0000, v29
    v_cvt_pk_bf16_f32 v92, v92, v92
    v_lshlrev_b32 v92, 16, v92
    v_mul_f32 v92, v92, v14
    v_mul_f32 v35, s61, v92
    v_mul_f32 v93, v93, v14
    v_mul_f32 v43, s62, v93
    v_mul_f32 v94, v94, v14
    v_add_f32 v51, v94, v94
    v_mul_f32 v95, v95, v14
    v_add_f32 v59, v95, v95

    v_lshlrev_b32 v92, 16, v18
    v_mul_f32 v92, s60, v92
    v_exp_f32 v92, v92

    v_lshlrev_b32 v93, 16, v22
    v_lshlrev_b32 v94, 16, v26
    v_lshlrev_b32 v95, 16, v30
    v_cvt_pk_bf16_f32 v92, v92, v92
    v_lshlrev_b32 v92, 16, v92
    v_mul_f32 v92, v92, v14
    v_mul_f32 v36, s61, v92
    v_mul_f32 v93, v93, v14
    v_mul_f32 v44, s62, v93
    v_mul_f32 v94, v94, v14
    v_add_f32 v52, v94, v94
    v_mul_f32 v95, v95, v14
    v_add_f32 v60, v95, v95

    v_and_b32 v92, 0xffff0000, v18
    v_mul_f32 v92, s60, v92
    v_exp_f32 v92, v92

    v_and_b32 v93, 0xffff0000, v22
    v_and_b32 v94, 0xffff0000, v26
    v_and_b32 v95, 0xffff0000, v30
    v_cvt_pk_bf16_f32 v92, v92, v92
    v_lshlrev_b32 v92, 16, v92
    v_mul_f32 v92, v92, v14
    v_mul_f32 v37, s61, v92
    v_mul_f32 v93, v93, v14
    v_mul_f32 v45, s62, v93
    v_mul_f32 v94, v94, v14
    v_add_f32 v53, v94, v94
    v_mul_f32 v95, v95, v14
    v_add_f32 v61, v95, v95

    v_lshlrev_b32 v92, 16, v19
    v_mul_f32 v92, s60, v92
    v_exp_f32 v92, v92

    v_lshlrev_b32 v93, 16, v23
    v_lshlrev_b32 v94, 16, v27
    v_lshlrev_b32 v95, 16, v31
    v_cvt_pk_bf16_f32 v92, v92, v92
    v_lshlrev_b32 v92, 16, v92
    v_mul_f32 v92, v92, v14
    v_mul_f32 v38, s61, v92
    v_mul_f32 v93, v93, v14
    v_mul_f32 v46, s62, v93
    v_mul_f32 v94, v94, v14
    v_add_f32 v54, v94, v94
    v_mul_f32 v95, v95, v14
    v_add_f32 v62, v95, v95

    v_and_b32 v92, 0xffff0000, v19
    v_mul_f32 v92, s60, v92
    v_exp_f32 v92, v92

    v_and_b32 v93, 0xffff0000, v23
    v_and_b32 v94, 0xffff0000, v27
    v_and_b32 v95, 0xffff0000, v31
    v_cvt_pk_bf16_f32 v92, v92, v92
    v_lshlrev_b32 v92, 16, v92
    v_mul_f32 v92, v92, v14
    v_mul_f32 v39, s61, v92
    v_mul_f32 v93, v93, v14
    v_mul_f32 v47, s62, v93
    v_mul_f32 v94, v94, v14
    v_add_f32 v55, v94, v94
    v_mul_f32 v95, v95, v14
    v_add_f32 v63, v95, v95

    v_mov_b32 v64, 0
    v_mov_b32 v65, 0
    v_mov_b32 v66, 0
    v_mov_b32 v67, 0
    v_mov_b32 v68, 0
    v_mov_b32 v69, 0
    v_mov_b32 v70, 0
    v_mov_b32 v71, 0
    v_mov_b32 v72, 0
    v_mov_b32 v73, 0
    v_mov_b32 v74, 0
    v_mov_b32 v75, 0
    v_lshlrev_b32 v112, 4, v2
    v_mov_b32 v113, v2
    v_cvt_f32_u32 v112, v112
    v_cvt_f32_u32 v113, v113
    v_mul_f32 v92, v32, v112
    v_mul_f32 v93, v40, v112
    v_mul_f32 v96, v32, v113
    v_mul_f32 v97, v40, v113
    v_exp_f32 v92, v92
    v_fract_f32 v93, v93
    v_exp_f32 v96, v96
    v_fract_f32 v97, v97
    v_cos_f32 v94, v93
    v_sin_f32 v95, v93
    v_cos_f32 v98, v97
    v_sin_f32 v99, v97
    s_nop 0
    v_mul_f32 v94, v92, v94
    v_mul_f32 v95, v92, v95
    v_mul_f32 v98, v96, v98
    v_mul_f32 v99, v96, v99
    v_mul_f32 v100, v48, v94
    v_mul_f32 v101, v48, v95
    v_fma_f32 v100, -v56, v95, v100
    v_fma_f32 v101, v56, v94, v101
    v_sub_f32 v101, 0, v101
    v_cvt_pk_bf16_f32 v76, v100, v101
    v_cvt_pk_bf16_f32 v84, v98, v99
    v_lshlrev_b32 v102, 16, v76
    v_and_b32 v103, 0xffff0000, v76
    v_lshlrev_b32 v104, 16, v84
    v_and_b32 v105, 0xffff0000, v84
    v_sub_f32 v100, v100, v102
    v_sub_f32 v101, v101, v103
    v_sub_f32 v98, v98, v104
    v_sub_f32 v99, v99, v105
    v_cvt_pk_bf16_f32 v80, v100, v101
    v_cvt_pk_bf16_f32 v88, v98, v99

    v_mul_f32 v92, v33, v112
    v_mul_f32 v93, v41, v112
    v_mul_f32 v96, v33, v113
    v_mul_f32 v97, v41, v113
    v_exp_f32 v92, v92
    v_fract_f32 v93, v93
    v_exp_f32 v96, v96
    v_fract_f32 v97, v97
    v_cos_f32 v94, v93
    v_sin_f32 v95, v93
    v_cos_f32 v98, v97
    v_sin_f32 v99, v97
    s_nop 0
    v_mul_f32 v94, v92, v94
    v_mul_f32 v95, v92, v95
    v_mul_f32 v98, v96, v98
    v_mul_f32 v99, v96, v99
    v_mul_f32 v100, v49, v94
    v_mul_f32 v101, v49, v95
    v_fma_f32 v100, -v57, v95, v100
    v_fma_f32 v101, v57, v94, v101
    v_sub_f32 v101, 0, v101
    v_cvt_pk_bf16_f32 v77, v100, v101
    v_cvt_pk_bf16_f32 v85, v98, v99
    v_lshlrev_b32 v102, 16, v77
    v_and_b32 v103, 0xffff0000, v77
    v_lshlrev_b32 v104, 16, v85
    v_and_b32 v105, 0xffff0000, v85
    v_sub_f32 v100, v100, v102
    v_sub_f32 v101, v101, v103
    v_sub_f32 v98, v98, v104
    v_sub_f32 v99, v99, v105
    v_cvt_pk_bf16_f32 v81, v100, v101
    v_cvt_pk_bf16_f32 v89, v98, v99

    v_mul_f32 v92, v34, v112
    v_mul_f32 v93, v42, v112
    v_mul_f32 v96, v34, v113
    v_mul_f32 v97, v42, v113
    v_exp_f32 v92, v92
    v_fract_f32 v93, v93
    v_exp_f32 v96, v96
    v_fract_f32 v97, v97
    v_cos_f32 v94, v93
    v_sin_f32 v95, v93
    v_cos_f32 v98, v97
    v_sin_f32 v99, v97
    s_nop 0
    v_mul_f32 v94, v92, v94
    v_mul_f32 v95, v92, v95
    v_mul_f32 v98, v96, v98
    v_mul_f32 v99, v96, v99
    v_mul_f32 v100, v50, v94
    v_mul_f32 v101, v50, v95
    v_fma_f32 v100, -v58, v95, v100
    v_fma_f32 v101, v58, v94, v101
    v_sub_f32 v101, 0, v101
    v_cvt_pk_bf16_f32 v78, v100, v101
    v_cvt_pk_bf16_f32 v86, v98, v99
    v_lshlrev_b32 v102, 16, v78
    v_and_b32 v103, 0xffff0000, v78
    v_lshlrev_b32 v104, 16, v86
    v_and_b32 v105, 0xffff0000, v86
    v_sub_f32 v100, v100, v102
    v_sub_f32 v101, v101, v103
    v_sub_f32 v98, v98, v104
    v_sub_f32 v99, v99, v105
    v_cvt_pk_bf16_f32 v82, v100, v101
    v_cvt_pk_bf16_f32 v90, v98, v99

    v_mul_f32 v92, v35, v112
    v_mul_f32 v93, v43, v112
    v_mul_f32 v96, v35, v113
    v_mul_f32 v97, v43, v113
    v_exp_f32 v92, v92
    v_fract_f32 v93, v93
    v_exp_f32 v96, v96
    v_fract_f32 v97, v97
    v_cos_f32 v94, v93
    v_sin_f32 v95, v93
    v_cos_f32 v98, v97
    v_sin_f32 v99, v97
    s_nop 0
    v_mul_f32 v94, v92, v94
    v_mul_f32 v95, v92, v95
    v_mul_f32 v98, v96, v98
    v_mul_f32 v99, v96, v99
    v_mul_f32 v100, v51, v94
    v_mul_f32 v101, v51, v95
    v_fma_f32 v100, -v59, v95, v100
    v_fma_f32 v101, v59, v94, v101
    v_sub_f32 v101, 0, v101
    v_cvt_pk_bf16_f32 v79, v100, v101
    v_cvt_pk_bf16_f32 v87, v98, v99
    v_lshlrev_b32 v102, 16, v79
    v_and_b32 v103, 0xffff0000, v79
    v_lshlrev_b32 v104, 16, v87
    v_and_b32 v105, 0xffff0000, v87
    v_sub_f32 v100, v100, v102
    v_sub_f32 v101, v101, v103
    v_sub_f32 v98, v98, v104
    v_sub_f32 v99, v99, v105
    v_cvt_pk_bf16_f32 v83, v100, v101
    v_cvt_pk_bf16_f32 v91, v98, v99

    s_nop 1
    v_mfma_f32_16x16x32_bf16 v[64:67], v[76:79], v[84:87], v[64:67]
    v_mfma_f32_16x16x32_bf16 v[64:67], v[76:79], v[88:91], v[64:67]
    v_mfma_f32_16x16x32_bf16 v[64:67], v[80:83], v[84:87], v[64:67]
    v_mul_f32 v92, v36, v112
    v_mul_f32 v93, v44, v112
    v_mul_f32 v96, v36, v113
    v_mul_f32 v97, v44, v113
    v_exp_f32 v92, v92
    v_fract_f32 v93, v93
    v_exp_f32 v96, v96
    v_fract_f32 v97, v97
    v_cos_f32 v94, v93
    v_sin_f32 v95, v93
    v_cos_f32 v98, v97
    v_sin_f32 v99, v97
    s_nop 0
    v_mul_f32 v94, v92, v94
    v_mul_f32 v95, v92, v95
    v_mul_f32 v98, v96, v98
    v_mul_f32 v99, v96, v99
    v_mul_f32 v100, v52, v94
    v_mul_f32 v101, v52, v95
    v_fma_f32 v100, -v60, v95, v100
    v_fma_f32 v101, v60, v94, v101
    v_sub_f32 v101, 0, v101
    v_cvt_pk_bf16_f32 v76, v100, v101
    v_cvt_pk_bf16_f32 v84, v98, v99
    v_lshlrev_b32 v102, 16, v76
    v_and_b32 v103, 0xffff0000, v76
    v_lshlrev_b32 v104, 16, v84
    v_and_b32 v105, 0xffff0000, v84
    v_sub_f32 v100, v100, v102
    v_sub_f32 v101, v101, v103
    v_sub_f32 v98, v98, v104
    v_sub_f32 v99, v99, v105
    v_cvt_pk_bf16_f32 v80, v100, v101
    v_cvt_pk_bf16_f32 v88, v98, v99

    v_mul_f32 v92, v37, v112
    v_mul_f32 v93, v45, v112
    v_mul_f32 v96, v37, v113
    v_mul_f32 v97, v45, v113
    v_exp_f32 v92, v92
    v_fract_f32 v93, v93
    v_exp_f32 v96, v96
    v_fract_f32 v97, v97
    v_cos_f32 v94, v93
    v_sin_f32 v95, v93
    v_cos_f32 v98, v97
    v_sin_f32 v99, v97
    s_nop 0
    v_mul_f32 v94, v92, v94
    v_mul_f32 v95, v92, v95
    v_mul_f32 v98, v96, v98
    v_mul_f32 v99, v96, v99
    v_mul_f32 v100, v53, v94
    v_mul_f32 v101, v53, v95
    v_fma_f32 v100, -v61, v95, v100
    v_fma_f32 v101, v61, v94, v101
    v_sub_f32 v101, 0, v101
    v_cvt_pk_bf16_f32 v77, v100, v101
    v_cvt_pk_bf16_f32 v85, v98, v99
    v_lshlrev_b32 v102, 16, v77
    v_and_b32 v103, 0xffff0000, v77
    v_lshlrev_b32 v104, 16, v85
    v_and_b32 v105, 0xffff0000, v85
    v_sub_f32 v100, v100, v102
    v_sub_f32 v101, v101, v103
    v_sub_f32 v98, v98, v104
    v_sub_f32 v99, v99, v105
    v_cvt_pk_bf16_f32 v81, v100, v101
    v_cvt_pk_bf16_f32 v89, v98, v99

    v_mul_f32 v92, v38, v112
    v_mul_f32 v93, v46, v112
    v_mul_f32 v96, v38, v113
    v_mul_f32 v97, v46, v113
    v_exp_f32 v92, v92
    v_fract_f32 v93, v93
    v_exp_f32 v96, v96
    v_fract_f32 v97, v97
    v_cos_f32 v94, v93
    v_sin_f32 v95, v93
    v_cos_f32 v98, v97
    v_sin_f32 v99, v97
    s_nop 0
    v_mul_f32 v94, v92, v94
    v_mul_f32 v95, v92, v95
    v_mul_f32 v98, v96, v98
    v_mul_f32 v99, v96, v99
    v_mul_f32 v100, v54, v94
    v_mul_f32 v101, v54, v95
    v_fma_f32 v100, -v62, v95, v100
    v_fma_f32 v101, v62, v94, v101
    v_sub_f32 v101, 0, v101
    v_cvt_pk_bf16_f32 v78, v100, v101
    v_cvt_pk_bf16_f32 v86, v98, v99
    v_lshlrev_b32 v102, 16, v78
    v_and_b32 v103, 0xffff0000, v78
    v_lshlrev_b32 v104, 16, v86
    v_and_b32 v105, 0xffff0000, v86
    v_sub_f32 v100, v100, v102
    v_sub_f32 v101, v101, v103
    v_sub_f32 v98, v98, v104
    v_sub_f32 v99, v99, v105
    v_cvt_pk_bf16_f32 v82, v100, v101
    v_cvt_pk_bf16_f32 v90, v98, v99

    v_mul_f32 v92, v39, v112
    v_mul_f32 v93, v47, v112
    v_mul_f32 v96, v39, v113
    v_mul_f32 v97, v47, v113
    v_exp_f32 v92, v92
    v_fract_f32 v93, v93
    v_exp_f32 v96, v96
    v_fract_f32 v97, v97
    v_cos_f32 v94, v93
    v_sin_f32 v95, v93
    v_cos_f32 v98, v97
    v_sin_f32 v99, v97
    s_nop 0
    v_mul_f32 v94, v92, v94
    v_mul_f32 v95, v92, v95
    v_mul_f32 v98, v96, v98
    v_mul_f32 v99, v96, v99
    v_mul_f32 v100, v55, v94
    v_mul_f32 v101, v55, v95
    v_fma_f32 v100, -v63, v95, v100
    v_fma_f32 v101, v63, v94, v101
    v_sub_f32 v101, 0, v101
    v_cvt_pk_bf16_f32 v79, v100, v101
    v_cvt_pk_bf16_f32 v87, v98, v99
    v_lshlrev_b32 v102, 16, v79
    v_and_b32 v103, 0xffff0000, v79
    v_lshlrev_b32 v104, 16, v87
    v_and_b32 v105, 0xffff0000, v87
    v_sub_f32 v100, v100, v102
    v_sub_f32 v101, v101, v103
    v_sub_f32 v98, v98, v104
    v_sub_f32 v99, v99, v105
    v_cvt_pk_bf16_f32 v83, v100, v101
    v_cvt_pk_bf16_f32 v91, v98, v99

    s_nop 1
    v_mfma_f32_16x16x32_bf16 v[64:67], v[76:79], v[84:87], v[64:67]
    v_mfma_f32_16x16x32_bf16 v[64:67], v[76:79], v[88:91], v[64:67]
    v_mfma_f32_16x16x32_bf16 v[64:67], v[80:83], v[84:87], v[64:67]
    v_lshrrev_b32 v112, 1, v2
    v_lshlrev_b32 v112, 6, v112
    v_and_b32 v113, 1, v2
    v_lshl_add_u32 v112, v113, 1, v112
    v_add_u32 v112, 0x100, v112
    v_subrev_u32 v113, 8, v2
    v_lshlrev_b32 v113, 6, v113
    v_add_u32 v113, 0x200, v113
    v_cmp_gt_u32 vcc, 8, v2
    s_nop 1
    v_cndmask_b32 v112, v113, v112, vcc
    v_lshlrev_b32 v113, 2, v2

    v_cvt_f32_u32 v112, v112
    v_cvt_f32_u32 v113, v113
    v_mul_f32 v92, v32, v112
    v_mul_f32 v93, v40, v112
    v_mul_f32 v96, v32, v113
    v_mul_f32 v97, v40, v113
    v_exp_f32 v92, v92
    v_fract_f32 v93, v93
    v_exp_f32 v96, v96
    v_fract_f32 v97, v97
    v_cos_f32 v94, v93
    v_sin_f32 v95, v93
    v_cos_f32 v98, v97
    v_sin_f32 v99, v97
    s_nop 0
    v_mul_f32 v94, v92, v94
    v_mul_f32 v95, v92, v95
    v_mul_f32 v98, v96, v98
    v_mul_f32 v99, v96, v99
    v_mul_f32 v100, v48, v94
    v_mul_f32 v101, v48, v95
    v_fma_f32 v100, -v56, v95, v100
    v_fma_f32 v101, v56, v94, v101
    v_sub_f32 v101, 0, v101
    v_cvt_pk_bf16_f32 v76, v100, v101
    v_cvt_pk_bf16_f32 v84, v98, v99
    v_lshlrev_b32 v102, 16, v76
    v_and_b32 v103, 0xffff0000, v76
    v_lshlrev_b32 v104, 16, v84
    v_and_b32 v105, 0xffff0000, v84
    v_sub_f32 v100, v100, v102
    v_sub_f32 v101, v101, v103
    v_sub_f32 v98, v98, v104
    v_sub_f32 v99, v99, v105
    v_cvt_pk_bf16_f32 v80, v100, v101
    v_cvt_pk_bf16_f32 v88, v98, v99

    v_mul_f32 v92, v33, v112
    v_mul_f32 v93, v41, v112
    v_mul_f32 v96, v33, v113
    v_mul_f32 v97, v41, v113
    v_exp_f32 v92, v92
    v_fract_f32 v93, v93
    v_exp_f32 v96, v96
    v_fract_f32 v97, v97
    v_cos_f32 v94, v93
    v_sin_f32 v95, v93
    v_cos_f32 v98, v97
    v_sin_f32 v99, v97
    s_nop 0
    v_mul_f32 v94, v92, v94
    v_mul_f32 v95, v92, v95
    v_mul_f32 v98, v96, v98
    v_mul_f32 v99, v96, v99
    v_mul_f32 v100, v49, v94
    v_mul_f32 v101, v49, v95
    v_fma_f32 v100, -v57, v95, v100
    v_fma_f32 v101, v57, v94, v101
    v_sub_f32 v101, 0, v101
    v_cvt_pk_bf16_f32 v77, v100, v101
    v_cvt_pk_bf16_f32 v85, v98, v99
    v_lshlrev_b32 v102, 16, v77
    v_and_b32 v103, 0xffff0000, v77
    v_lshlrev_b32 v104, 16, v85
    v_and_b32 v105, 0xffff0000, v85
    v_sub_f32 v100, v100, v102
    v_sub_f32 v101, v101, v103
    v_sub_f32 v98, v98, v104
    v_sub_f32 v99, v99, v105
    v_cvt_pk_bf16_f32 v81, v100, v101
    v_cvt_pk_bf16_f32 v89, v98, v99

    v_mul_f32 v92, v34, v112
    v_mul_f32 v93, v42, v112
    v_mul_f32 v96, v34, v113
    v_mul_f32 v97, v42, v113
    v_exp_f32 v92, v92
    v_fract_f32 v93, v93
    v_exp_f32 v96, v96
    v_fract_f32 v97, v97
    v_cos_f32 v94, v93
    v_sin_f32 v95, v93
    v_cos_f32 v98, v97
    v_sin_f32 v99, v97
    s_nop 0
    v_mul_f32 v94, v92, v94
    v_mul_f32 v95, v92, v95
    v_mul_f32 v98, v96, v98
    v_mul_f32 v99, v96, v99
    v_mul_f32 v100, v50, v94
    v_mul_f32 v101, v50, v95
    v_fma_f32 v100, -v58, v95, v100
    v_fma_f32 v101, v58, v94, v101
    v_sub_f32 v101, 0, v101
    v_cvt_pk_bf16_f32 v78, v100, v101
    v_cvt_pk_bf16_f32 v86, v98, v99
    v_lshlrev_b32 v102, 16, v78
    v_and_b32 v103, 0xffff0000, v78
    v_lshlrev_b32 v104, 16, v86
    v_and_b32 v105, 0xffff0000, v86
    v_sub_f32 v100, v100, v102
    v_sub_f32 v101, v101, v103
    v_sub_f32 v98, v98, v104
    v_sub_f32 v99, v99, v105
    v_cvt_pk_bf16_f32 v82, v100, v101
    v_cvt_pk_bf16_f32 v90, v98, v99

    v_mul_f32 v92, v35, v112
    v_mul_f32 v93, v43, v112
    v_mul_f32 v96, v35, v113
    v_mul_f32 v97, v43, v113
    v_exp_f32 v92, v92
    v_fract_f32 v93, v93
    v_exp_f32 v96, v96
    v_fract_f32 v97, v97
    v_cos_f32 v94, v93
    v_sin_f32 v95, v93
    v_cos_f32 v98, v97
    v_sin_f32 v99, v97
    s_nop 0
    v_mul_f32 v94, v92, v94
    v_mul_f32 v95, v92, v95
    v_mul_f32 v98, v96, v98
    v_mul_f32 v99, v96, v99
    v_mul_f32 v100, v51, v94
    v_mul_f32 v101, v51, v95
    v_fma_f32 v100, -v59, v95, v100
    v_fma_f32 v101, v59, v94, v101
    v_sub_f32 v101, 0, v101
    v_cvt_pk_bf16_f32 v79, v100, v101
    v_cvt_pk_bf16_f32 v87, v98, v99
    v_lshlrev_b32 v102, 16, v79
    v_and_b32 v103, 0xffff0000, v79
    v_lshlrev_b32 v104, 16, v87
    v_and_b32 v105, 0xffff0000, v87
    v_sub_f32 v100, v100, v102
    v_sub_f32 v101, v101, v103
    v_sub_f32 v98, v98, v104
    v_sub_f32 v99, v99, v105
    v_cvt_pk_bf16_f32 v83, v100, v101
    v_cvt_pk_bf16_f32 v91, v98, v99

    s_nop 1
    v_mfma_f32_16x16x32_bf16 v[68:71], v[76:79], v[84:87], v[68:71]
    v_mfma_f32_16x16x32_bf16 v[68:71], v[76:79], v[88:91], v[68:71]
    v_mfma_f32_16x16x32_bf16 v[68:71], v[80:83], v[84:87], v[68:71]
    v_mul_f32 v92, v36, v112
    v_mul_f32 v93, v44, v112
    v_mul_f32 v96, v36, v113
    v_mul_f32 v97, v44, v113
    v_exp_f32 v92, v92
    v_fract_f32 v93, v93
    v_exp_f32 v96, v96
    v_fract_f32 v97, v97
    v_cos_f32 v94, v93
    v_sin_f32 v95, v93
    v_cos_f32 v98, v97
    v_sin_f32 v99, v97
    s_nop 0
    v_mul_f32 v94, v92, v94
    v_mul_f32 v95, v92, v95
    v_mul_f32 v98, v96, v98
    v_mul_f32 v99, v96, v99
    v_mul_f32 v100, v52, v94
    v_mul_f32 v101, v52, v95
    v_fma_f32 v100, -v60, v95, v100
    v_fma_f32 v101, v60, v94, v101
    v_sub_f32 v101, 0, v101
    v_cvt_pk_bf16_f32 v76, v100, v101
    v_cvt_pk_bf16_f32 v84, v98, v99
    v_lshlrev_b32 v102, 16, v76
    v_and_b32 v103, 0xffff0000, v76
    v_lshlrev_b32 v104, 16, v84
    v_and_b32 v105, 0xffff0000, v84
    v_sub_f32 v100, v100, v102
    v_sub_f32 v101, v101, v103
    v_sub_f32 v98, v98, v104
    v_sub_f32 v99, v99, v105
    v_cvt_pk_bf16_f32 v80, v100, v101
    v_cvt_pk_bf16_f32 v88, v98, v99

    v_mul_f32 v92, v37, v112
    v_mul_f32 v93, v45, v112
    v_mul_f32 v96, v37, v113
    v_mul_f32 v97, v45, v113
    v_exp_f32 v92, v92
    v_fract_f32 v93, v93
    v_exp_f32 v96, v96
    v_fract_f32 v97, v97
    v_cos_f32 v94, v93
    v_sin_f32 v95, v93
    v_cos_f32 v98, v97
    v_sin_f32 v99, v97
    s_nop 0
    v_mul_f32 v94, v92, v94
    v_mul_f32 v95, v92, v95
    v_mul_f32 v98, v96, v98
    v_mul_f32 v99, v96, v99
    v_mul_f32 v100, v53, v94
    v_mul_f32 v101, v53, v95
    v_fma_f32 v100, -v61, v95, v100
    v_fma_f32 v101, v61, v94, v101
    v_sub_f32 v101, 0, v101
    v_cvt_pk_bf16_f32 v77, v100, v101
    v_cvt_pk_bf16_f32 v85, v98, v99
    v_lshlrev_b32 v102, 16, v77
    v_and_b32 v103, 0xffff0000, v77
    v_lshlrev_b32 v104, 16, v85
    v_and_b32 v105, 0xffff0000, v85
    v_sub_f32 v100, v100, v102
    v_sub_f32 v101, v101, v103
    v_sub_f32 v98, v98, v104
    v_sub_f32 v99, v99, v105
    v_cvt_pk_bf16_f32 v81, v100, v101
    v_cvt_pk_bf16_f32 v89, v98, v99

    v_mul_f32 v92, v38, v112
    v_mul_f32 v93, v46, v112
    v_mul_f32 v96, v38, v113
    v_mul_f32 v97, v46, v113
    v_exp_f32 v92, v92
    v_fract_f32 v93, v93
    v_exp_f32 v96, v96
    v_fract_f32 v97, v97
    v_cos_f32 v94, v93
    v_sin_f32 v95, v93
    v_cos_f32 v98, v97
    v_sin_f32 v99, v97
    s_nop 0
    v_mul_f32 v94, v92, v94
    v_mul_f32 v95, v92, v95
    v_mul_f32 v98, v96, v98
    v_mul_f32 v99, v96, v99
    v_mul_f32 v100, v54, v94
    v_mul_f32 v101, v54, v95
    v_fma_f32 v100, -v62, v95, v100
    v_fma_f32 v101, v62, v94, v101
    v_sub_f32 v101, 0, v101
    v_cvt_pk_bf16_f32 v78, v100, v101
    v_cvt_pk_bf16_f32 v86, v98, v99
    v_lshlrev_b32 v102, 16, v78
    v_and_b32 v103, 0xffff0000, v78
    v_lshlrev_b32 v104, 16, v86
    v_and_b32 v105, 0xffff0000, v86
    v_sub_f32 v100, v100, v102
    v_sub_f32 v101, v101, v103
    v_sub_f32 v98, v98, v104
    v_sub_f32 v99, v99, v105
    v_cvt_pk_bf16_f32 v82, v100, v101
    v_cvt_pk_bf16_f32 v90, v98, v99

    v_mul_f32 v92, v39, v112
    v_mul_f32 v93, v47, v112
    v_mul_f32 v96, v39, v113
    v_mul_f32 v97, v47, v113
    v_exp_f32 v92, v92
    v_fract_f32 v93, v93
    v_exp_f32 v96, v96
    v_fract_f32 v97, v97
    v_cos_f32 v94, v93
    v_sin_f32 v95, v93
    v_cos_f32 v98, v97
    v_sin_f32 v99, v97
    s_nop 0
    v_mul_f32 v94, v92, v94
    v_mul_f32 v95, v92, v95
    v_mul_f32 v98, v96, v98
    v_mul_f32 v99, v96, v99
    v_mul_f32 v100, v55, v94
    v_mul_f32 v101, v55, v95
    v_fma_f32 v100, -v63, v95, v100
    v_fma_f32 v101, v63, v94, v101
    v_sub_f32 v101, 0, v101
    v_cvt_pk_bf16_f32 v79, v100, v101
    v_cvt_pk_bf16_f32 v87, v98, v99
    v_lshlrev_b32 v102, 16, v79
    v_and_b32 v103, 0xffff0000, v79
    v_lshlrev_b32 v104, 16, v87
    v_and_b32 v105, 0xffff0000, v87
    v_sub_f32 v100, v100, v102
    v_sub_f32 v101, v101, v103
    v_sub_f32 v98, v98, v104
    v_sub_f32 v99, v99, v105
    v_cvt_pk_bf16_f32 v83, v100, v101
    v_cvt_pk_bf16_f32 v91, v98, v99

    s_nop 1
    v_mfma_f32_16x16x32_bf16 v[68:71], v[76:79], v[84:87], v[68:71]
    v_mfma_f32_16x16x32_bf16 v[68:71], v[76:79], v[88:91], v[68:71]
    v_mfma_f32_16x16x32_bf16 v[68:71], v[80:83], v[84:87], v[68:71]
    v_lshlrev_b32 v112, 7, v2
    v_add_u32 v112, 0x400, v112
    v_lshlrev_b32 v113, 3, v2

    v_cvt_f32_u32 v112, v112
    v_cvt_f32_u32 v113, v113
    v_mul_f32 v92, v32, v112
    v_mul_f32 v93, v40, v112
    v_mul_f32 v96, v32, v113
    v_mul_f32 v97, v40, v113
    v_exp_f32 v92, v92
    v_fract_f32 v93, v93
    v_exp_f32 v96, v96
    v_fract_f32 v97, v97
    v_cos_f32 v94, v93
    v_sin_f32 v95, v93
    v_cos_f32 v98, v97
    v_sin_f32 v99, v97
    s_nop 0
    v_mul_f32 v94, v92, v94
    v_mul_f32 v95, v92, v95
    v_mul_f32 v98, v96, v98
    v_mul_f32 v99, v96, v99
    v_mul_f32 v100, v48, v94
    v_mul_f32 v101, v48, v95
    v_fma_f32 v100, -v56, v95, v100
    v_fma_f32 v101, v56, v94, v101
    v_sub_f32 v101, 0, v101
    v_cvt_pk_bf16_f32 v76, v100, v101
    v_cvt_pk_bf16_f32 v84, v98, v99
    v_lshlrev_b32 v102, 16, v76
    v_and_b32 v103, 0xffff0000, v76
    v_lshlrev_b32 v104, 16, v84
    v_and_b32 v105, 0xffff0000, v84
    v_sub_f32 v100, v100, v102
    v_sub_f32 v101, v101, v103
    v_sub_f32 v98, v98, v104
    v_sub_f32 v99, v99, v105
    v_cvt_pk_bf16_f32 v80, v100, v101
    v_cvt_pk_bf16_f32 v88, v98, v99

    v_mul_f32 v92, v33, v112
    v_mul_f32 v93, v41, v112
    v_mul_f32 v96, v33, v113
    v_mul_f32 v97, v41, v113
    v_exp_f32 v92, v92
    v_fract_f32 v93, v93
    v_exp_f32 v96, v96
    v_fract_f32 v97, v97
    v_cos_f32 v94, v93
    v_sin_f32 v95, v93
    v_cos_f32 v98, v97
    v_sin_f32 v99, v97
    s_nop 0
    v_mul_f32 v94, v92, v94
    v_mul_f32 v95, v92, v95
    v_mul_f32 v98, v96, v98
    v_mul_f32 v99, v96, v99
    v_mul_f32 v100, v49, v94
    v_mul_f32 v101, v49, v95
    v_fma_f32 v100, -v57, v95, v100
    v_fma_f32 v101, v57, v94, v101
    v_sub_f32 v101, 0, v101
    v_cvt_pk_bf16_f32 v77, v100, v101
    v_cvt_pk_bf16_f32 v85, v98, v99
    v_lshlrev_b32 v102, 16, v77
    v_and_b32 v103, 0xffff0000, v77
    v_lshlrev_b32 v104, 16, v85
    v_and_b32 v105, 0xffff0000, v85
    v_sub_f32 v100, v100, v102
    v_sub_f32 v101, v101, v103
    v_sub_f32 v98, v98, v104
    v_sub_f32 v99, v99, v105
    v_cvt_pk_bf16_f32 v81, v100, v101
    v_cvt_pk_bf16_f32 v89, v98, v99

    v_mul_f32 v92, v34, v112
    v_mul_f32 v93, v42, v112
    v_mul_f32 v96, v34, v113
    v_mul_f32 v97, v42, v113
    v_exp_f32 v92, v92
    v_fract_f32 v93, v93
    v_exp_f32 v96, v96
    v_fract_f32 v97, v97
    v_cos_f32 v94, v93
    v_sin_f32 v95, v93
    v_cos_f32 v98, v97
    v_sin_f32 v99, v97
    s_nop 0
    v_mul_f32 v94, v92, v94
    v_mul_f32 v95, v92, v95
    v_mul_f32 v98, v96, v98
    v_mul_f32 v99, v96, v99
    v_mul_f32 v100, v50, v94
    v_mul_f32 v101, v50, v95
    v_fma_f32 v100, -v58, v95, v100
    v_fma_f32 v101, v58, v94, v101
    v_sub_f32 v101, 0, v101
    v_cvt_pk_bf16_f32 v78, v100, v101
    v_cvt_pk_bf16_f32 v86, v98, v99
    v_lshlrev_b32 v102, 16, v78
    v_and_b32 v103, 0xffff0000, v78
    v_lshlrev_b32 v104, 16, v86
    v_and_b32 v105, 0xffff0000, v86
    v_sub_f32 v100, v100, v102
    v_sub_f32 v101, v101, v103
    v_sub_f32 v98, v98, v104
    v_sub_f32 v99, v99, v105
    v_cvt_pk_bf16_f32 v82, v100, v101
    v_cvt_pk_bf16_f32 v90, v98, v99

    v_mul_f32 v92, v35, v112
    v_mul_f32 v93, v43, v112
    v_mul_f32 v96, v35, v113
    v_mul_f32 v97, v43, v113
    v_exp_f32 v92, v92
    v_fract_f32 v93, v93
    v_exp_f32 v96, v96
    v_fract_f32 v97, v97
    v_cos_f32 v94, v93
    v_sin_f32 v95, v93
    v_cos_f32 v98, v97
    v_sin_f32 v99, v97
    s_nop 0
    v_mul_f32 v94, v92, v94
    v_mul_f32 v95, v92, v95
    v_mul_f32 v98, v96, v98
    v_mul_f32 v99, v96, v99
    v_mul_f32 v100, v51, v94
    v_mul_f32 v101, v51, v95
    v_fma_f32 v100, -v59, v95, v100
    v_fma_f32 v101, v59, v94, v101
    v_sub_f32 v101, 0, v101
    v_cvt_pk_bf16_f32 v79, v100, v101
    v_cvt_pk_bf16_f32 v87, v98, v99
    v_lshlrev_b32 v102, 16, v79
    v_and_b32 v103, 0xffff0000, v79
    v_lshlrev_b32 v104, 16, v87
    v_and_b32 v105, 0xffff0000, v87
    v_sub_f32 v100, v100, v102
    v_sub_f32 v101, v101, v103
    v_sub_f32 v98, v98, v104
    v_sub_f32 v99, v99, v105
    v_cvt_pk_bf16_f32 v83, v100, v101
    v_cvt_pk_bf16_f32 v91, v98, v99

    s_nop 1
    v_mfma_f32_16x16x32_bf16 v[72:75], v[76:79], v[84:87], v[72:75]
    v_mfma_f32_16x16x32_bf16 v[72:75], v[76:79], v[88:91], v[72:75]
    v_mfma_f32_16x16x32_bf16 v[72:75], v[80:83], v[84:87], v[72:75]
    v_mul_f32 v92, v36, v112
    v_mul_f32 v93, v44, v112
    v_mul_f32 v96, v36, v113
    v_mul_f32 v97, v44, v113
    v_exp_f32 v92, v92
    v_fract_f32 v93, v93
    v_exp_f32 v96, v96
    v_fract_f32 v97, v97
    v_cos_f32 v94, v93
    v_sin_f32 v95, v93
    v_cos_f32 v98, v97
    v_sin_f32 v99, v97
    s_nop 0
    v_mul_f32 v94, v92, v94
    v_mul_f32 v95, v92, v95
    v_mul_f32 v98, v96, v98
    v_mul_f32 v99, v96, v99
    v_mul_f32 v100, v52, v94
    v_mul_f32 v101, v52, v95
    v_fma_f32 v100, -v60, v95, v100
    v_fma_f32 v101, v60, v94, v101
    v_sub_f32 v101, 0, v101
    v_cvt_pk_bf16_f32 v76, v100, v101
    v_cvt_pk_bf16_f32 v84, v98, v99
    v_lshlrev_b32 v102, 16, v76
    v_and_b32 v103, 0xffff0000, v76
    v_lshlrev_b32 v104, 16, v84
    v_and_b32 v105, 0xffff0000, v84
    v_sub_f32 v100, v100, v102
    v_sub_f32 v101, v101, v103
    v_sub_f32 v98, v98, v104
    v_sub_f32 v99, v99, v105
    v_cvt_pk_bf16_f32 v80, v100, v101
    v_cvt_pk_bf16_f32 v88, v98, v99

    v_mul_f32 v92, v37, v112
    v_mul_f32 v93, v45, v112
    v_mul_f32 v96, v37, v113
    v_mul_f32 v97, v45, v113
    v_exp_f32 v92, v92
    v_fract_f32 v93, v93
    v_exp_f32 v96, v96
    v_fract_f32 v97, v97
    v_cos_f32 v94, v93
    v_sin_f32 v95, v93
    v_cos_f32 v98, v97
    v_sin_f32 v99, v97
    s_nop 0
    v_mul_f32 v94, v92, v94
    v_mul_f32 v95, v92, v95
    v_mul_f32 v98, v96, v98
    v_mul_f32 v99, v96, v99
    v_mul_f32 v100, v53, v94
    v_mul_f32 v101, v53, v95
    v_fma_f32 v100, -v61, v95, v100
    v_fma_f32 v101, v61, v94, v101
    v_sub_f32 v101, 0, v101
    v_cvt_pk_bf16_f32 v77, v100, v101
    v_cvt_pk_bf16_f32 v85, v98, v99
    v_lshlrev_b32 v102, 16, v77
    v_and_b32 v103, 0xffff0000, v77
    v_lshlrev_b32 v104, 16, v85
    v_and_b32 v105, 0xffff0000, v85
    v_sub_f32 v100, v100, v102
    v_sub_f32 v101, v101, v103
    v_sub_f32 v98, v98, v104
    v_sub_f32 v99, v99, v105
    v_cvt_pk_bf16_f32 v81, v100, v101
    v_cvt_pk_bf16_f32 v89, v98, v99

    v_mul_f32 v92, v38, v112
    v_mul_f32 v93, v46, v112
    v_mul_f32 v96, v38, v113
    v_mul_f32 v97, v46, v113
    v_exp_f32 v92, v92
    v_fract_f32 v93, v93
    v_exp_f32 v96, v96
    v_fract_f32 v97, v97
    v_cos_f32 v94, v93
    v_sin_f32 v95, v93
    v_cos_f32 v98, v97
    v_sin_f32 v99, v97
    s_nop 0
    v_mul_f32 v94, v92, v94
    v_mul_f32 v95, v92, v95
    v_mul_f32 v98, v96, v98
    v_mul_f32 v99, v96, v99
    v_mul_f32 v100, v54, v94
    v_mul_f32 v101, v54, v95
    v_fma_f32 v100, -v62, v95, v100
    v_fma_f32 v101, v62, v94, v101
    v_sub_f32 v101, 0, v101
    v_cvt_pk_bf16_f32 v78, v100, v101
    v_cvt_pk_bf16_f32 v86, v98, v99
    v_lshlrev_b32 v102, 16, v78
    v_and_b32 v103, 0xffff0000, v78
    v_lshlrev_b32 v104, 16, v86
    v_and_b32 v105, 0xffff0000, v86
    v_sub_f32 v100, v100, v102
    v_sub_f32 v101, v101, v103
    v_sub_f32 v98, v98, v104
    v_sub_f32 v99, v99, v105
    v_cvt_pk_bf16_f32 v82, v100, v101
    v_cvt_pk_bf16_f32 v90, v98, v99

    v_mul_f32 v92, v39, v112
    v_mul_f32 v93, v47, v112
    v_mul_f32 v96, v39, v113
    v_mul_f32 v97, v47, v113
    v_exp_f32 v92, v92
    v_fract_f32 v93, v93
    v_exp_f32 v96, v96
    v_fract_f32 v97, v97
    v_cos_f32 v94, v93
    v_sin_f32 v95, v93
    v_cos_f32 v98, v97
    v_sin_f32 v99, v97
    s_nop 0
    v_mul_f32 v94, v92, v94
    v_mul_f32 v95, v92, v95
    v_mul_f32 v98, v96, v98
    v_mul_f32 v99, v96, v99
    v_mul_f32 v100, v55, v94
    v_mul_f32 v101, v55, v95
    v_fma_f32 v100, -v63, v95, v100
    v_fma_f32 v101, v63, v94, v101
    v_sub_f32 v101, 0, v101
    v_cvt_pk_bf16_f32 v79, v100, v101
    v_cvt_pk_bf16_f32 v87, v98, v99
    v_lshlrev_b32 v102, 16, v79
    v_and_b32 v103, 0xffff0000, v79
    v_lshlrev_b32 v104, 16, v87
    v_and_b32 v105, 0xffff0000, v87
    v_sub_f32 v100, v100, v102
    v_sub_f32 v101, v101, v103
    v_sub_f32 v98, v98, v104
    v_sub_f32 v99, v99, v105
    v_cvt_pk_bf16_f32 v83, v100, v101
    v_cvt_pk_bf16_f32 v91, v98, v99

    s_nop 1
    v_mfma_f32_16x16x32_bf16 v[72:75], v[76:79], v[84:87], v[72:75]
    v_mfma_f32_16x16x32_bf16 v[72:75], v[76:79], v[88:91], v[72:75]
    v_mfma_f32_16x16x32_bf16 v[72:75], v[80:83], v[84:87], v[72:75]
    v_lshlrev_b32 v92, 6, v3
    v_add_u32 v92, v92, v2
    v_lshlrev_b32 v92, 4, v92
    s_lshl_b32 s55, s3, 2
    v_add_u32 v92, s55, v92
    s_nop 7
    s_nop 3

    ds_write_b32 v92, v64 offset:19712
    ds_write_b32 v92, v65 offset:19968
    ds_write_b32 v92, v66 offset:20224
    ds_write_b32 v92, v67 offset:20480
    ds_write_b32 v92, v68 offset:23808
    ds_write_b32 v92, v69 offset:24064
    ds_write_b32 v92, v70 offset:24320
    ds_write_b32 v92, v71 offset:24576
    ds_write_b32 v92, v72 offset:27904
    ds_write_b32 v92, v73 offset:28160
    ds_write_b32 v92, v74 offset:28416
    ds_write_b32 v92, v75 offset:28672
    v_lshlrev_b32 v7, 1, v0
    v_sub_u32 v7, 4094, v7
    s_waitcnt vmcnt(0)
    v_subrev_u32 v93, 0, v7
    ds_write_b16 v93, v114
    v_subrev_u32 v93, 512, v7
    ds_write_b16 v93, v115
    v_subrev_u32 v93, 1024, v7
    ds_write_b16 v93, v116
    v_subrev_u32 v93, 1536, v7
    ds_write_b16 v93, v117
    v_subrev_u32 v93, 2048, v7
    ds_write_b16 v93, v118
    v_subrev_u32 v93, 2560, v7
    ds_write_b16 v93, v119
    v_subrev_u32 v93, 3072, v7
    ds_write_b16 v93, v120
    v_subrev_u32 v93, 3584, v7
    ds_write_b16 v93, v121
    s_waitcnt lgkmcnt(0)
    s_barrier
    v_lshlrev_b32 v92, 3, v0
    v_add_u32 v92, 0, v92
    v_cvt_f32_u32 v93, v92
    v_bfe_u32 v94, v93, 16, 1
    v_add3_u32 v93, v93, v94, s63
    v_lshrrev_b32 v94, 23, v93
    v_bfe_u32 v95, v93, 16, 7
    v_subrev_u32 v96, 136, v94
    v_lshlrev_b32 v96, 7, v96
    v_add3_u32 v96, v96, v95, s64
    v_and_b32 v97, 96, v95
    v_and_b32 v98, 1, v95
    v_lshl_add_u32 v97, v98, 4, v97
    v_bfe_u32 v98, v95, 1, 4
    v_add3_u32 v97, v97, v98, s65
    v_cmp_eq_u32 vcc, 135, v94
    s_nop 1
    v_cndmask_b32 v96, v96, v97, vcc
    v_cmp_gt_u32 vcc, 135, v94
    s_nop 1
    v_cndmask_b32 v96, v96, v92, vcc
    v_lshlrev_b32 v96, 4, v96
    ds_read_b128 v[16:19], v96 offset:19712

    v_lshlrev_b32 v92, 3, v0
    v_add_u32 v92, 1, v92
    v_cvt_f32_u32 v93, v92
    v_bfe_u32 v94, v93, 16, 1
    v_add3_u32 v93, v93, v94, s63
    v_lshrrev_b32 v94, 23, v93
    v_bfe_u32 v95, v93, 16, 7
    v_subrev_u32 v96, 136, v94
    v_lshlrev_b32 v96, 7, v96
    v_add3_u32 v96, v96, v95, s64
    v_and_b32 v97, 96, v95
    v_and_b32 v98, 1, v95
    v_lshl_add_u32 v97, v98, 4, v97
    v_bfe_u32 v98, v95, 1, 4
    v_add3_u32 v97, v97, v98, s65
    v_cmp_eq_u32 vcc, 135, v94
    s_nop 1
    v_cndmask_b32 v96, v96, v97, vcc
    v_cmp_gt_u32 vcc, 135, v94
    s_nop 1
    v_cndmask_b32 v96, v96, v92, vcc
    v_lshlrev_b32 v96, 4, v96
    ds_read_b128 v[20:23], v96 offset:19712

    v_lshlrev_b32 v92, 3, v0
    v_add_u32 v92, 2, v92
    v_cvt_f32_u32 v93, v92
    v_bfe_u32 v94, v93, 16, 1
    v_add3_u32 v93, v93, v94, s63
    v_lshrrev_b32 v94, 23, v93
    v_bfe_u32 v95, v93, 16, 7
    v_subrev_u32 v96, 136, v94
    v_lshlrev_b32 v96, 7, v96
    v_add3_u32 v96, v96, v95, s64
    v_and_b32 v97, 96, v95
    v_and_b32 v98, 1, v95
    v_lshl_add_u32 v97, v98, 4, v97
    v_bfe_u32 v98, v95, 1, 4
    v_add3_u32 v97, v97, v98, s65
    v_cmp_eq_u32 vcc, 135, v94
    s_nop 1
    v_cndmask_b32 v96, v96, v97, vcc
    v_cmp_gt_u32 vcc, 135, v94
    s_nop 1
    v_cndmask_b32 v96, v96, v92, vcc
    v_lshlrev_b32 v96, 4, v96
    ds_read_b128 v[24:27], v96 offset:19712

    v_lshlrev_b32 v92, 3, v0
    v_add_u32 v92, 3, v92
    v_cvt_f32_u32 v93, v92
    v_bfe_u32 v94, v93, 16, 1
    v_add3_u32 v93, v93, v94, s63
    v_lshrrev_b32 v94, 23, v93
    v_bfe_u32 v95, v93, 16, 7
    v_subrev_u32 v96, 136, v94
    v_lshlrev_b32 v96, 7, v96
    v_add3_u32 v96, v96, v95, s64
    v_and_b32 v97, 96, v95
    v_and_b32 v98, 1, v95
    v_lshl_add_u32 v97, v98, 4, v97
    v_bfe_u32 v98, v95, 1, 4
    v_add3_u32 v97, v97, v98, s65
    v_cmp_eq_u32 vcc, 135, v94
    s_nop 1
    v_cndmask_b32 v96, v96, v97, vcc
    v_cmp_gt_u32 vcc, 135, v94
    s_nop 1
    v_cndmask_b32 v96, v96, v92, vcc
    v_lshlrev_b32 v96, 4, v96
    ds_read_b128 v[28:31], v96 offset:19712

    v_lshlrev_b32 v92, 3, v0
    v_add_u32 v92, 4, v92
    v_cvt_f32_u32 v93, v92
    v_bfe_u32 v94, v93, 16, 1
    v_add3_u32 v93, v93, v94, s63
    v_lshrrev_b32 v94, 23, v93
    v_bfe_u32 v95, v93, 16, 7
    v_subrev_u32 v96, 136, v94
    v_lshlrev_b32 v96, 7, v96
    v_add3_u32 v96, v96, v95, s64
    v_and_b32 v97, 96, v95
    v_and_b32 v98, 1, v95
    v_lshl_add_u32 v97, v98, 4, v97
    v_bfe_u32 v98, v95, 1, 4
    v_add3_u32 v97, v97, v98, s65
    v_cmp_eq_u32 vcc, 135, v94
    s_nop 1
    v_cndmask_b32 v96, v96, v97, vcc
    v_cmp_gt_u32 vcc, 135, v94
    s_nop 1
    v_cndmask_b32 v96, v96, v92, vcc
    v_lshlrev_b32 v96, 4, v96
    ds_read_b128 v[32:35], v96 offset:19712

    v_lshlrev_b32 v92, 3, v0
    v_add_u32 v92, 5, v92
    v_cvt_f32_u32 v93, v92
    v_bfe_u32 v94, v93, 16, 1
    v_add3_u32 v93, v93, v94, s63
    v_lshrrev_b32 v94, 23, v93
    v_bfe_u32 v95, v93, 16, 7
    v_subrev_u32 v96, 136, v94
    v_lshlrev_b32 v96, 7, v96
    v_add3_u32 v96, v96, v95, s64
    v_and_b32 v97, 96, v95
    v_and_b32 v98, 1, v95
    v_lshl_add_u32 v97, v98, 4, v97
    v_bfe_u32 v98, v95, 1, 4
    v_add3_u32 v97, v97, v98, s65
    v_cmp_eq_u32 vcc, 135, v94
    s_nop 1
    v_cndmask_b32 v96, v96, v97, vcc
    v_cmp_gt_u32 vcc, 135, v94
    s_nop 1
    v_cndmask_b32 v96, v96, v92, vcc
    v_lshlrev_b32 v96, 4, v96
    ds_read_b128 v[36:39], v96 offset:19712

    v_lshlrev_b32 v92, 3, v0
    v_add_u32 v92, 6, v92
    v_cvt_f32_u32 v93, v92
    v_bfe_u32 v94, v93, 16, 1
    v_add3_u32 v93, v93, v94, s63
    v_lshrrev_b32 v94, 23, v93
    v_bfe_u32 v95, v93, 16, 7
    v_subrev_u32 v96, 136, v94
    v_lshlrev_b32 v96, 7, v96
    v_add3_u32 v96, v96, v95, s64
    v_and_b32 v97, 96, v95
    v_and_b32 v98, 1, v95
    v_lshl_add_u32 v97, v98, 4, v97
    v_bfe_u32 v98, v95, 1, 4
    v_add3_u32 v97, v97, v98, s65
    v_cmp_eq_u32 vcc, 135, v94
    s_nop 1
    v_cndmask_b32 v96, v96, v97, vcc
    v_cmp_gt_u32 vcc, 135, v94
    s_nop 1
    v_cndmask_b32 v96, v96, v92, vcc
    v_lshlrev_b32 v96, 4, v96
    ds_read_b128 v[40:43], v96 offset:19712

    v_lshlrev_b32 v92, 3, v0
    v_add_u32 v92, 7, v92
    v_cvt_f32_u32 v93, v92
    v_bfe_u32 v94, v93, 16, 1
    v_add3_u32 v93, v93, v94, s63
    v_lshrrev_b32 v94, 23, v93
    v_bfe_u32 v95, v93, 16, 7
    v_subrev_u32 v96, 136, v94
    v_lshlrev_b32 v96, 7, v96
    v_add3_u32 v96, v96, v95, s64
    v_and_b32 v97, 96, v95
    v_and_b32 v98, 1, v95
    v_lshl_add_u32 v97, v98, 4, v97
    v_bfe_u32 v98, v95, 1, 4
    v_add3_u32 v97, v97, v98, s65
    v_cmp_eq_u32 vcc, 135, v94
    s_nop 1
    v_cndmask_b32 v96, v96, v97, vcc
    v_cmp_gt_u32 vcc, 135, v94
    s_nop 1
    v_cndmask_b32 v96, v96, v92, vcc
    v_lshlrev_b32 v96, 4, v96
    ds_read_b128 v[44:47], v96 offset:19712

    s_waitcnt lgkmcnt(0)
    v_add_f32 v16, v16, v17
    v_add_f32 v18, v18, v19
    v_add_f32 v16, v16, v18
    v_add_f32 v20, v20, v21
    v_add_f32 v22, v22, v23
    v_add_f32 v20, v20, v22
    v_add_f32 v24, v24, v25
    v_add_f32 v26, v26, v27
    v_add_f32 v24, v24, v26
    v_add_f32 v28, v28, v29
    v_add_f32 v30, v30, v31
    v_add_f32 v28, v28, v30
    v_add_f32 v32, v32, v33
    v_add_f32 v34, v34, v35
    v_add_f32 v32, v32, v34
    v_add_f32 v36, v36, v37
    v_add_f32 v38, v38, v39
    v_add_f32 v36, v36, v38
    v_add_f32 v40, v40, v41
    v_add_f32 v42, v42, v43
    v_add_f32 v40, v40, v42
    v_add_f32 v44, v44, v45
    v_add_f32 v46, v46, v47
    v_add_f32 v44, v44, v46
    v_cvt_pk_bf16_f32 v48, v16, v20
    v_lshlrev_b32 v92, 16, v48
    v_and_b32 v93, 0xffff0000, v48
    v_sub_f32 v92, v16, v92
    v_sub_f32 v93, v20, v93
    v_cvt_pk_bf16_f32 v52, v92, v93

    v_cvt_pk_bf16_f32 v49, v24, v28
    v_lshlrev_b32 v92, 16, v49
    v_and_b32 v93, 0xffff0000, v49
    v_sub_f32 v92, v24, v92
    v_sub_f32 v93, v28, v93
    v_cvt_pk_bf16_f32 v53, v92, v93

    v_cvt_pk_bf16_f32 v50, v32, v36
    v_lshlrev_b32 v92, 16, v50
    v_and_b32 v93, 0xffff0000, v50
    v_sub_f32 v92, v32, v92
    v_sub_f32 v93, v36, v93
    v_cvt_pk_bf16_f32 v54, v92, v93

    v_cvt_pk_bf16_f32 v51, v40, v44
    v_lshlrev_b32 v92, 16, v51
    v_and_b32 v93, 0xffff0000, v51
    v_sub_f32 v92, v40, v92
    v_sub_f32 v93, v44, v93
    v_cvt_pk_bf16_f32 v55, v92, v93

    v_lshrrev_b32 v92, 2, v0
    v_mul_u32_u24 v92, 80, v92
    v_and_b32 v93, 3, v0
    v_lshl_add_u32 v92, v93, 4, v92
    ds_write_b128 v92, v[48:51] offset:6832
    ds_write_b128 v92, v[52:55] offset:14512
    s_waitcnt lgkmcnt(0)
    s_barrier

    v_mov_b32 v16, 0
    v_mov_b32 v17, 0
    v_mov_b32 v18, 0
    v_mov_b32 v19, 0
    v_mov_b32 v20, 0
    v_mov_b32 v21, 0
    v_mov_b32 v22, 0
    v_mov_b32 v23, 0
    v_mov_b32 v24, 0
    v_mov_b32 v25, 0
    v_mov_b32 v26, 0
    v_mov_b32 v27, 0
    v_mov_b32 v28, 0
    v_mov_b32 v29, 0
    v_mov_b32 v30, 0
    v_mov_b32 v31, 0
    v_mov_b32 v32, 0
    v_mov_b32 v33, 0
    v_mov_b32 v34, 0
    v_mov_b32 v35, 0
    v_mov_b32 v36, 0
    v_mov_b32 v37, 0
    v_mov_b32 v38, 0
    v_mov_b32 v39, 0
    v_mov_b32 v40, 0
    v_mov_b32 v41, 0
    v_mov_b32 v42, 0
    v_mov_b32 v43, 0
    v_mov_b32 v44, 0
    v_mov_b32 v45, 0
    v_mov_b32 v46, 0
    v_mov_b32 v47, 0
    v_lshlrev_b32 v6, 1, v5
    v_sub_u32 v6, 4094, v6
    v_lshl_add_u32 v6, v4, 4, v6
    s_lshl_b32 s55, s3, 6
    v_subrev_u32 v6, s55, v6
    v_mul_u32_u24 v7, 80, v5
    v_lshl_add_u32 v7, v4, 4, v7
    v_add_u32 v7, 2480, v7
    s_mul_i32 s55, s3, 80
    v_subrev_u32 v7, s55, v7

    v_subrev_u32 v8, 0, v6
    v_subrev_u32 v9, 0, v7
    ds_read_b128 v[48:51], v8 offset:0
    ds_read_b128 v[52:55], v8 offset:32
    ds_read_b128 v[56:59], v9 offset:4352
    ds_read_b128 v[60:63], v9 offset:4384
    ds_read_b128 v[64:67], v9 offset:12032
    ds_read_b128 v[68:71], v9 offset:12064
    ds_read_b128 v[72:75], v9 offset:6912
    ds_read_b128 v[76:79], v9 offset:6944
    ds_read_b128 v[80:83], v9 offset:14592
    ds_read_b128 v[84:87], v9 offset:14624
    v_subrev_u32 v8, 256, v6
    v_subrev_u32 v9, 320, v7
    ds_read_b128 v[88:91], v8 offset:0
    ds_read_b128 v[92:95], v8 offset:32
    ds_read_b128 v[96:99], v9 offset:4352
    ds_read_b128 v[100:103], v9 offset:4384
    ds_read_b128 v[104:107], v9 offset:12032
    ds_read_b128 v[108:111], v9 offset:12064
    ds_read_b128 v[112:115], v9 offset:6912
    ds_read_b128 v[116:119], v9 offset:6944
    ds_read_b128 v[120:123], v9 offset:14592
    ds_read_b128 v[124:127], v9 offset:14624
    s_waitcnt lgkmcnt(10)
    v_mfma_f32_32x32x16_bf16 v[16:31], v[48:51], v[56:59], v[16:31]
    v_mfma_f32_32x32x16_bf16 v[16:31], v[52:55], v[60:63], v[16:31]
    v_mfma_f32_32x32x16_bf16 v[16:31], v[48:51], v[64:67], v[16:31]
    v_mfma_f32_32x32x16_bf16 v[16:31], v[52:55], v[68:71], v[16:31]
    v_mfma_f32_32x32x16_bf16 v[32:47], v[48:51], v[72:75], v[32:47]
    v_mfma_f32_32x32x16_bf16 v[32:47], v[52:55], v[76:79], v[32:47]
    v_mfma_f32_32x32x16_bf16 v[32:47], v[48:51], v[80:83], v[32:47]
    v_mfma_f32_32x32x16_bf16 v[32:47], v[52:55], v[84:87], v[32:47]
    v_subrev_u32 v8, 512, v6
    v_subrev_u32 v9, 640, v7
    ds_read_b128 v[48:51], v8 offset:0
    ds_read_b128 v[52:55], v8 offset:32
    ds_read_b128 v[56:59], v9 offset:4352
    ds_read_b128 v[60:63], v9 offset:4384
    ds_read_b128 v[64:67], v9 offset:12032
    ds_read_b128 v[68:71], v9 offset:12064
    ds_read_b128 v[72:75], v9 offset:6912
    ds_read_b128 v[76:79], v9 offset:6944
    ds_read_b128 v[80:83], v9 offset:14592
    ds_read_b128 v[84:87], v9 offset:14624
    s_waitcnt lgkmcnt(10)
    v_mfma_f32_32x32x16_bf16 v[16:31], v[88:91], v[96:99], v[16:31]
    v_mfma_f32_32x32x16_bf16 v[16:31], v[92:95], v[100:103], v[16:31]
    v_mfma_f32_32x32x16_bf16 v[16:31], v[88:91], v[104:107], v[16:31]
    v_mfma_f32_32x32x16_bf16 v[16:31], v[92:95], v[108:111], v[16:31]
    v_mfma_f32_32x32x16_bf16 v[32:47], v[88:91], v[112:115], v[32:47]
    v_mfma_f32_32x32x16_bf16 v[32:47], v[92:95], v[116:119], v[32:47]
    v_mfma_f32_32x32x16_bf16 v[32:47], v[88:91], v[120:123], v[32:47]
    v_mfma_f32_32x32x16_bf16 v[32:47], v[92:95], v[124:127], v[32:47]
    v_subrev_u32 v8, 768, v6
    v_subrev_u32 v9, 960, v7
    ds_read_b128 v[88:91], v8 offset:0
    ds_read_b128 v[92:95], v8 offset:32
    ds_read_b128 v[96:99], v9 offset:4352
    ds_read_b128 v[100:103], v9 offset:4384
    ds_read_b128 v[104:107], v9 offset:12032
    ds_read_b128 v[108:111], v9 offset:12064
    ds_read_b128 v[112:115], v9 offset:6912
    ds_read_b128 v[116:119], v9 offset:6944
    ds_read_b128 v[120:123], v9 offset:14592
    ds_read_b128 v[124:127], v9 offset:14624
    s_waitcnt lgkmcnt(10)
    v_mfma_f32_32x32x16_bf16 v[16:31], v[48:51], v[56:59], v[16:31]
    v_mfma_f32_32x32x16_bf16 v[16:31], v[52:55], v[60:63], v[16:31]
    v_mfma_f32_32x32x16_bf16 v[16:31], v[48:51], v[64:67], v[16:31]
    v_mfma_f32_32x32x16_bf16 v[16:31], v[52:55], v[68:71], v[16:31]
    v_mfma_f32_32x32x16_bf16 v[32:47], v[48:51], v[72:75], v[32:47]
    v_mfma_f32_32x32x16_bf16 v[32:47], v[52:55], v[76:79], v[32:47]
    v_mfma_f32_32x32x16_bf16 v[32:47], v[48:51], v[80:83], v[32:47]
    v_mfma_f32_32x32x16_bf16 v[32:47], v[52:55], v[84:87], v[32:47]
    v_subrev_u32 v8, 1024, v6
    v_subrev_u32 v9, 1280, v7
    ds_read_b128 v[48:51], v8 offset:0
    ds_read_b128 v[52:55], v8 offset:32
    ds_read_b128 v[56:59], v9 offset:4352
    ds_read_b128 v[60:63], v9 offset:4384
    ds_read_b128 v[64:67], v9 offset:12032
    ds_read_b128 v[68:71], v9 offset:12064
    ds_read_b128 v[72:75], v9 offset:6912
    ds_read_b128 v[76:79], v9 offset:6944
    ds_read_b128 v[80:83], v9 offset:14592
    ds_read_b128 v[84:87], v9 offset:14624
    s_waitcnt lgkmcnt(10)
    v_mfma_f32_32x32x16_bf16 v[16:31], v[88:91], v[96:99], v[16:31]
    v_mfma_f32_32x32x16_bf16 v[16:31], v[92:95], v[100:103], v[16:31]
    v_mfma_f32_32x32x16_bf16 v[16:31], v[88:91], v[104:107], v[16:31]
    v_mfma_f32_32x32x16_bf16 v[16:31], v[92:95], v[108:111], v[16:31]
    v_mfma_f32_32x32x16_bf16 v[32:47], v[88:91], v[112:115], v[32:47]
    v_mfma_f32_32x32x16_bf16 v[32:47], v[92:95], v[116:119], v[32:47]
    v_mfma_f32_32x32x16_bf16 v[32:47], v[88:91], v[120:123], v[32:47]
    v_mfma_f32_32x32x16_bf16 v[32:47], v[92:95], v[124:127], v[32:47]
    v_subrev_u32 v8, 1280, v6
    v_subrev_u32 v9, 1600, v7
    ds_read_b128 v[88:91], v8 offset:0
    ds_read_b128 v[92:95], v8 offset:32
    ds_read_b128 v[96:99], v9 offset:4352
    ds_read_b128 v[100:103], v9 offset:4384
    ds_read_b128 v[104:107], v9 offset:12032
    ds_read_b128 v[108:111], v9 offset:12064
    ds_read_b128 v[112:115], v9 offset:6912
    ds_read_b128 v[116:119], v9 offset:6944
    ds_read_b128 v[120:123], v9 offset:14592
    ds_read_b128 v[124:127], v9 offset:14624
    s_waitcnt lgkmcnt(10)
    v_mfma_f32_32x32x16_bf16 v[16:31], v[48:51], v[56:59], v[16:31]
    v_mfma_f32_32x32x16_bf16 v[16:31], v[52:55], v[60:63], v[16:31]
    v_mfma_f32_32x32x16_bf16 v[16:31], v[48:51], v[64:67], v[16:31]
    v_mfma_f32_32x32x16_bf16 v[16:31], v[52:55], v[68:71], v[16:31]
    v_mfma_f32_32x32x16_bf16 v[32:47], v[48:51], v[72:75], v[32:47]
    v_mfma_f32_32x32x16_bf16 v[32:47], v[52:55], v[76:79], v[32:47]
    v_mfma_f32_32x32x16_bf16 v[32:47], v[48:51], v[80:83], v[32:47]
    v_mfma_f32_32x32x16_bf16 v[32:47], v[52:55], v[84:87], v[32:47]
    v_subrev_u32 v8, 1536, v6
    v_subrev_u32 v9, 1920, v7
    ds_read_b128 v[48:51], v8 offset:0
    ds_read_b128 v[52:55], v8 offset:32
    ds_read_b128 v[56:59], v9 offset:4352
    ds_read_b128 v[60:63], v9 offset:4384
    ds_read_b128 v[64:67], v9 offset:12032
    ds_read_b128 v[68:71], v9 offset:12064
    ds_read_b128 v[72:75], v9 offset:6912
    ds_read_b128 v[76:79], v9 offset:6944
    ds_read_b128 v[80:83], v9 offset:14592
    ds_read_b128 v[84:87], v9 offset:14624
    s_waitcnt lgkmcnt(10)
    v_mfma_f32_32x32x16_bf16 v[16:31], v[88:91], v[96:99], v[16:31]
    v_mfma_f32_32x32x16_bf16 v[16:31], v[92:95], v[100:103], v[16:31]
    v_mfma_f32_32x32x16_bf16 v[16:31], v[88:91], v[104:107], v[16:31]
    v_mfma_f32_32x32x16_bf16 v[16:31], v[92:95], v[108:111], v[16:31]
    v_mfma_f32_32x32x16_bf16 v[32:47], v[88:91], v[112:115], v[32:47]
    v_mfma_f32_32x32x16_bf16 v[32:47], v[92:95], v[116:119], v[32:47]
    v_mfma_f32_32x32x16_bf16 v[32:47], v[88:91], v[120:123], v[32:47]
    v_mfma_f32_32x32x16_bf16 v[32:47], v[92:95], v[124:127], v[32:47]
    v_subrev_u32 v8, 1792, v6
    v_subrev_u32 v9, 2240, v7
    ds_read_b128 v[88:91], v8 offset:0
    ds_read_b128 v[92:95], v8 offset:32
    ds_read_b128 v[96:99], v9 offset:4352
    ds_read_b128 v[100:103], v9 offset:4384
    ds_read_b128 v[104:107], v9 offset:12032
    ds_read_b128 v[108:111], v9 offset:12064
    ds_read_b128 v[112:115], v9 offset:6912
    ds_read_b128 v[116:119], v9 offset:6944
    ds_read_b128 v[120:123], v9 offset:14592
    ds_read_b128 v[124:127], v9 offset:14624
    s_waitcnt lgkmcnt(10)
    v_mfma_f32_32x32x16_bf16 v[16:31], v[48:51], v[56:59], v[16:31]
    v_mfma_f32_32x32x16_bf16 v[16:31], v[52:55], v[60:63], v[16:31]
    v_mfma_f32_32x32x16_bf16 v[16:31], v[48:51], v[64:67], v[16:31]
    v_mfma_f32_32x32x16_bf16 v[16:31], v[52:55], v[68:71], v[16:31]
    v_mfma_f32_32x32x16_bf16 v[32:47], v[48:51], v[72:75], v[32:47]
    v_mfma_f32_32x32x16_bf16 v[32:47], v[52:55], v[76:79], v[32:47]
    v_mfma_f32_32x32x16_bf16 v[32:47], v[48:51], v[80:83], v[32:47]
    v_mfma_f32_32x32x16_bf16 v[32:47], v[52:55], v[84:87], v[32:47]
    v_subrev_u32 v8, 2048, v6
    v_subrev_u32 v9, 2560, v7
    ds_read_b128 v[48:51], v8 offset:0
    ds_read_b128 v[52:55], v8 offset:32
    ds_read_b128 v[72:75], v9 offset:6912
    ds_read_b128 v[76:79], v9 offset:6944
    ds_read_b128 v[80:83], v9 offset:14592
    ds_read_b128 v[84:87], v9 offset:14624
    s_waitcnt lgkmcnt(6)
    v_mfma_f32_32x32x16_bf16 v[16:31], v[88:91], v[96:99], v[16:31]
    v_mfma_f32_32x32x16_bf16 v[16:31], v[92:95], v[100:103], v[16:31]
    v_mfma_f32_32x32x16_bf16 v[16:31], v[88:91], v[104:107], v[16:31]
    v_mfma_f32_32x32x16_bf16 v[16:31], v[92:95], v[108:111], v[16:31]
    v_mfma_f32_32x32x16_bf16 v[32:47], v[88:91], v[112:115], v[32:47]
    v_mfma_f32_32x32x16_bf16 v[32:47], v[92:95], v[116:119], v[32:47]
    v_mfma_f32_32x32x16_bf16 v[32:47], v[88:91], v[120:123], v[32:47]
    v_mfma_f32_32x32x16_bf16 v[32:47], v[92:95], v[124:127], v[32:47]
    v_subrev_u32 v8, 2304, v6
    v_subrev_u32 v9, 2880, v7
    ds_read_b128 v[88:91], v8 offset:0
    ds_read_b128 v[92:95], v8 offset:32
    ds_read_b128 v[112:115], v9 offset:6912
    ds_read_b128 v[116:119], v9 offset:6944
    ds_read_b128 v[120:123], v9 offset:14592
    ds_read_b128 v[124:127], v9 offset:14624
    s_waitcnt lgkmcnt(6)
    v_mfma_f32_32x32x16_bf16 v[32:47], v[48:51], v[72:75], v[32:47]
    v_mfma_f32_32x32x16_bf16 v[32:47], v[52:55], v[76:79], v[32:47]
    v_mfma_f32_32x32x16_bf16 v[32:47], v[48:51], v[80:83], v[32:47]
    v_mfma_f32_32x32x16_bf16 v[32:47], v[52:55], v[84:87], v[32:47]
    v_subrev_u32 v8, 2560, v6
    v_subrev_u32 v9, 3200, v7
    ds_read_b128 v[48:51], v8 offset:0
    ds_read_b128 v[52:55], v8 offset:32
    ds_read_b128 v[72:75], v9 offset:6912
    ds_read_b128 v[76:79], v9 offset:6944
    ds_read_b128 v[80:83], v9 offset:14592
    ds_read_b128 v[84:87], v9 offset:14624
    s_waitcnt lgkmcnt(6)
    v_mfma_f32_32x32x16_bf16 v[32:47], v[88:91], v[112:115], v[32:47]
    v_mfma_f32_32x32x16_bf16 v[32:47], v[92:95], v[116:119], v[32:47]
    v_mfma_f32_32x32x16_bf16 v[32:47], v[88:91], v[120:123], v[32:47]
    v_mfma_f32_32x32x16_bf16 v[32:47], v[92:95], v[124:127], v[32:47]
    v_subrev_u32 v8, 2816, v6
    v_subrev_u32 v9, 3520, v7
    ds_read_b128 v[88:91], v8 offset:0
    ds_read_b128 v[92:95], v8 offset:32
    ds_read_b128 v[112:115], v9 offset:6912
    ds_read_b128 v[116:119], v9 offset:6944
    ds_read_b128 v[120:123], v9 offset:14592
    ds_read_b128 v[124:127], v9 offset:14624
    s_waitcnt lgkmcnt(6)
    v_mfma_f32_32x32x16_bf16 v[32:47], v[48:51], v[72:75], v[32:47]
    v_mfma_f32_32x32x16_bf16 v[32:47], v[52:55], v[76:79], v[32:47]
    v_mfma_f32_32x32x16_bf16 v[32:47], v[48:51], v[80:83], v[32:47]
    v_mfma_f32_32x32x16_bf16 v[32:47], v[52:55], v[84:87], v[32:47]
    v_subrev_u32 v8, 3072, v6
    v_subrev_u32 v9, 3840, v7
    ds_read_b128 v[48:51], v8 offset:0
    ds_read_b128 v[52:55], v8 offset:32
    ds_read_b128 v[72:75], v9 offset:6912
    ds_read_b128 v[76:79], v9 offset:6944
    ds_read_b128 v[80:83], v9 offset:14592
    ds_read_b128 v[84:87], v9 offset:14624
    s_waitcnt lgkmcnt(6)
    v_mfma_f32_32x32x16_bf16 v[32:47], v[88:91], v[112:115], v[32:47]
    v_mfma_f32_32x32x16_bf16 v[32:47], v[92:95], v[116:119], v[32:47]
    v_mfma_f32_32x32x16_bf16 v[32:47], v[88:91], v[120:123], v[32:47]
    v_mfma_f32_32x32x16_bf16 v[32:47], v[92:95], v[124:127], v[32:47]
    v_subrev_u32 v8, 3328, v6
    v_subrev_u32 v9, 4160, v7
    ds_read_b128 v[88:91], v8 offset:0
    ds_read_b128 v[92:95], v8 offset:32
    ds_read_b128 v[112:115], v9 offset:6912
    ds_read_b128 v[116:119], v9 offset:6944
    ds_read_b128 v[120:123], v9 offset:14592
    ds_read_b128 v[124:127], v9 offset:14624
    s_waitcnt lgkmcnt(6)
    v_mfma_f32_32x32x16_bf16 v[32:47], v[48:51], v[72:75], v[32:47]
    v_mfma_f32_32x32x16_bf16 v[32:47], v[52:55], v[76:79], v[32:47]
    v_mfma_f32_32x32x16_bf16 v[32:47], v[48:51], v[80:83], v[32:47]
    v_mfma_f32_32x32x16_bf16 v[32:47], v[52:55], v[84:87], v[32:47]
    v_subrev_u32 v8, 3584, v6
    v_subrev_u32 v9, 4480, v7
    ds_read_b128 v[48:51], v8 offset:0
    ds_read_b128 v[52:55], v8 offset:32
    ds_read_b128 v[72:75], v9 offset:6912
    ds_read_b128 v[76:79], v9 offset:6944
    ds_read_b128 v[80:83], v9 offset:14592
    ds_read_b128 v[84:87], v9 offset:14624
    s_waitcnt lgkmcnt(6)
    v_mfma_f32_32x32x16_bf16 v[32:47], v[88:91], v[112:115], v[32:47]
    v_mfma_f32_32x32x16_bf16 v[32:47], v[92:95], v[116:119], v[32:47]
    v_mfma_f32_32x32x16_bf16 v[32:47], v[88:91], v[120:123], v[32:47]
    v_mfma_f32_32x32x16_bf16 v[32:47], v[92:95], v[124:127], v[32:47]
    v_subrev_u32 v8, 3840, v6
    v_subrev_u32 v9, 4800, v7
    ds_read_b128 v[88:91], v8 offset:0
    ds_read_b128 v[92:95], v8 offset:32
    ds_read_b128 v[112:115], v9 offset:6912
    ds_read_b128 v[116:119], v9 offset:6944
    ds_read_b128 v[120:123], v9 offset:14592
    ds_read_b128 v[124:127], v9 offset:14624
    s_waitcnt lgkmcnt(6)
    v_mfma_f32_32x32x16_bf16 v[32:47], v[48:51], v[72:75], v[32:47]
    v_mfma_f32_32x32x16_bf16 v[32:47], v[52:55], v[76:79], v[32:47]
    v_mfma_f32_32x32x16_bf16 v[32:47], v[48:51], v[80:83], v[32:47]
    v_mfma_f32_32x32x16_bf16 v[32:47], v[52:55], v[84:87], v[32:47]
    s_waitcnt lgkmcnt(0)
    v_mfma_f32_32x32x16_bf16 v[32:47], v[88:91], v[112:115], v[32:47]
    v_mfma_f32_32x32x16_bf16 v[32:47], v[92:95], v[116:119], v[32:47]
    v_mfma_f32_32x32x16_bf16 v[32:47], v[88:91], v[120:123], v[32:47]
    v_mfma_f32_32x32x16_bf16 v[32:47], v[92:95], v[124:127], v[32:47]
    v_lshlrev_b32 v8, 4, v1
    s_lshl_b32 s55, s3, 13
    v_add_u32 v8, s55, v8
    s_barrier
    s_nop 7
    s_nop 7

    ds_write_b128 v8, v[16:19] offset:4352
    ds_write_b128 v8, v[20:23] offset:5376
    ds_write_b128 v8, v[24:27] offset:6400
    ds_write_b128 v8, v[28:31] offset:7424
    ds_write_b128 v8, v[32:35] offset:8448
    ds_write_b128 v8, v[36:39] offset:9472
    ds_write_b128 v8, v[40:43] offset:10496
    ds_write_b128 v8, v[44:47] offset:11520
    s_waitcnt lgkmcnt(0)
    s_barrier
    s_lshr_b32 s55, s3, 1
    s_and_b32 s56, s3, 1
    s_lshl_b32 s56, s56, 1
    s_lshl_b32 s57, s55, 2
    s_add_u32 s57, s57, s56
    s_lshl_b32 s57, s57, 10
    v_lshlrev_b32 v8, 4, v1
    v_add_u32 v8, s57, v8
    s_lshl_b32 s57, s55, 10
    s_lshl_b32 s58, s56, 3
    s_add_u32 s57, s57, s58
    v_lshlrev_b32 v9, 5, v5
    v_lshl_add_u32 v9, v4, 2, v9
    v_add_u32 v9, s57, v9
    v_lshlrev_b32 v10, 1, v9
    v_sub_u32 v10, 4088, v10
    v_subrev_u32 v11, 16, v10
    ds_read_b64 v[60:61], v10
    ds_read_b64 v[62:63], v11
    s_lshl_b32 s57, s2, 12
    v_lshlrev_b32 v12, 1, v9
    v_add_u32 v12, s57, v12

    ds_read_b128 v[64:67], v8 offset:4352
    ds_read_b128 v[68:71], v8 offset:12544
    ds_read_b128 v[72:75], v8 offset:20736
    ds_read_b128 v[76:79], v8 offset:28928
    s_waitcnt lgkmcnt(0)
    v_add_f32 v64, v64, v68
    v_add_f32 v72, v72, v76
    v_add_f32 v65, v65, v69
    v_add_f32 v73, v73, v77
    v_add_f32 v66, v66, v70
    v_add_f32 v74, v74, v78
    v_add_f32 v67, v67, v71
    v_add_f32 v75, v75, v79
    v_add_f32 v64, v64, v72
    v_add_f32 v65, v65, v73
    v_add_f32 v66, v66, v74
    v_add_f32 v67, v67, v75
    v_cvt_pk_bf16_f32 v80, v64, v65
    v_cvt_pk_bf16_f32 v81, v66, v67
    v_lshlrev_b32 v64, 16, v80
    v_and_b32 v65, 0xffff0000, v80
    v_lshlrev_b32 v66, 16, v81
    v_and_b32 v67, 0xffff0000, v81
    v_and_b32 v82, 0xffff0000, v61
    v_lshlrev_b32 v83, 16, v61
    v_and_b32 v84, 0xffff0000, v60
    v_lshlrev_b32 v85, 16, v60
    v_mul_f32 v82, v82, v15
    v_mul_f32 v83, v83, v15
    v_mul_f32 v84, v84, v15
    v_mul_f32 v85, v85, v15
    v_cvt_pk_bf16_f32 v80, v82, v83
    v_cvt_pk_bf16_f32 v81, v84, v85
    v_lshlrev_b32 v82, 16, v80
    v_and_b32 v83, 0xffff0000, v80
    v_lshlrev_b32 v84, 16, v81
    v_and_b32 v85, 0xffff0000, v81
    v_add_f32 v82, v82, v64
    v_add_f32 v83, v83, v65
    v_add_f32 v84, v84, v66
    v_add_f32 v85, v85, v67
    v_cvt_pk_bf16_f32 v80, v82, v83
    v_cvt_pk_bf16_f32 v81, v84, v85
    buffer_store_dwordx2 v[80:81], v12, s[44:47], 0 offen offset:0

    ds_read_b128 v[64:67], v8 offset:5376
    ds_read_b128 v[68:71], v8 offset:13568
    ds_read_b128 v[72:75], v8 offset:21760
    ds_read_b128 v[76:79], v8 offset:29952
    s_waitcnt lgkmcnt(0)
    v_add_f32 v64, v64, v68
    v_add_f32 v72, v72, v76
    v_add_f32 v65, v65, v69
    v_add_f32 v73, v73, v77
    v_add_f32 v66, v66, v70
    v_add_f32 v74, v74, v78
    v_add_f32 v67, v67, v71
    v_add_f32 v75, v75, v79
    v_add_f32 v64, v64, v72
    v_add_f32 v65, v65, v73
    v_add_f32 v66, v66, v74
    v_add_f32 v67, v67, v75
    v_cvt_pk_bf16_f32 v80, v64, v65
    v_cvt_pk_bf16_f32 v81, v66, v67
    v_lshlrev_b32 v64, 16, v80
    v_and_b32 v65, 0xffff0000, v80
    v_lshlrev_b32 v66, 16, v81
    v_and_b32 v67, 0xffff0000, v81
    v_and_b32 v82, 0xffff0000, v63
    v_lshlrev_b32 v83, 16, v63
    v_and_b32 v84, 0xffff0000, v62
    v_lshlrev_b32 v85, 16, v62
    v_mul_f32 v82, v82, v15
    v_mul_f32 v83, v83, v15
    v_mul_f32 v84, v84, v15
    v_mul_f32 v85, v85, v15
    v_cvt_pk_bf16_f32 v80, v82, v83
    v_cvt_pk_bf16_f32 v81, v84, v85
    v_lshlrev_b32 v82, 16, v80
    v_and_b32 v83, 0xffff0000, v80
    v_lshlrev_b32 v84, 16, v81
    v_and_b32 v85, 0xffff0000, v81
    v_add_f32 v82, v82, v64
    v_add_f32 v83, v83, v65
    v_add_f32 v84, v84, v66
    v_add_f32 v85, v85, v67
    v_cvt_pk_bf16_f32 v80, v82, v83
    v_cvt_pk_bf16_f32 v81, v84, v85
    buffer_store_dwordx2 v[80:81], v12, s[44:47], 0 offen offset:16

    s_waitcnt vmcnt(0)
    s_endpgm
k1_end:
    s_endpgm
.globl k2_kernel
.p2align 8
.type k2_kernel,@function
k2_kernel:
    s_cmp_ge_u32 s2, 256
    s_cbranch_scc1 k2_end

    s_load_dwordx2 s[4:5], s[0:1], 104
    s_load_dwordx2 s[6:7], s[0:1], 88
    v_lshrrev_b32 v5, 6, v0
    v_and_b32 v1, 63, v0
    v_and_b32 v2, 15, v1
    v_lshrrev_b32 v3, 4, v1
    v_readfirstlane_b32 s8, v5
    s_and_b32 s9, s2, 31
    s_lshr_b32 s10, s2, 5
    v_lshrrev_b32 v6, 3, v0
    v_and_b32 v7, 7, v0
    v_mul_u32_u24 v4, 0xd80, v6
    v_lshl_add_u32 v4, v7, 4, v4
    v_mul_u32_u24 v5, 144, v6
    v_lshl_add_u32 v5, v7, 4, v5
    s_mul_i32 s47, s10, 276480
    s_mul_i32 s48, s9, 221184
    s_add_u32 s36, s47, 110592
    s_add_u32 s37, s47, 221184
    s_add_u32 s38, s48, 110592
    s_lshr_b32 s11, s8, 1
    s_and_b32 s12, s8, 1
    v_mul_u32_u24 v8, 144, v2
    v_lshl_add_u32 v8, v3, 4, v8
    s_lshl_b32 s13, s11, 6
    v_add_u32 v8, s13, v8
    s_mul_i32 s13, s12, 4608
    v_add_u32 v9, s13, v8
    s_waitcnt lgkmcnt(0)

    s_mov_b32 s16, s4
    s_mov_b32 s17, s5
    s_mov_b32 s18, 7077888
    s_mov_b32 s19, 0x00020000
    s_add_u32 s20, s4, 10485760
    s_addc_u32 s21, s5, 0
    s_mov_b32 s22, 2211840
    s_mov_b32 s23, 0x00020000
    s_add_u32 s24, s4, 7340032
    s_addc_u32 s25, s5, 0
    s_mov_b32 s26, 2621440
    s_mov_b32 s27, 0x00020000
    s_add_u32 s28, s4, 13631488
    s_addc_u32 s29, s5, 0
    s_mov_b32 s30, 8192
    s_mov_b32 s31, 0x00020000
    s_mov_b32 s32, s6
    s_mov_b32 s33, s7
    s_mov_b32 s34, 2621440
    s_mov_b32 s35, 0x00020000
    v_mov_b32 v16, 0
    v_mov_b32 v17, 0
    v_mov_b32 v18, 0
    v_mov_b32 v19, 0
    v_mov_b32 v20, 0
    v_mov_b32 v21, 0
    v_mov_b32 v22, 0
    v_mov_b32 v23, 0
    v_mov_b32 v24, 0
    v_mov_b32 v25, 0
    v_mov_b32 v26, 0
    v_mov_b32 v27, 0
    v_mov_b32 v28, 0
    v_mov_b32 v29, 0
    v_mov_b32 v30, 0
    v_mov_b32 v31, 0
    v_mov_b32 v32, 0
    v_mov_b32 v33, 0
    v_mov_b32 v34, 0
    v_mov_b32 v35, 0
    v_mov_b32 v36, 0
    v_mov_b32 v37, 0
    v_mov_b32 v38, 0
    v_mov_b32 v39, 0
    v_mov_b32 v40, 0
    v_mov_b32 v41, 0
    v_mov_b32 v42, 0
    v_mov_b32 v43, 0
    v_mov_b32 v44, 0
    v_mov_b32 v45, 0
    v_mov_b32 v46, 0
    v_mov_b32 v47, 0
    v_mov_b32 v48, 0
    v_mov_b32 v49, 0
    v_mov_b32 v50, 0
    v_mov_b32 v51, 0
    v_mov_b32 v52, 0
    v_mov_b32 v53, 0
    v_mov_b32 v54, 0
    v_mov_b32 v55, 0
    s_movk_i32 s39, 128
    v_cmp_gt_u32 s[40:41], s39, v0
    v_lshrrev_b32 v6, 3, v0
    v_and_b32 v7, 7, v0
    v_lshlrev_b32 v10, 12, v6
    v_lshl_add_u32 v10, v7, 4, v10
    s_mul_i32 s49, s10, 327680
    s_lshl_b32 s50, s9, 7
    s_add_u32 s49, s49, s50
    s_add_u32 s50, s49, 131072
    s_add_u32 s51, s49, 262144
    buffer_load_dwordx4 v[236:239], v10, s[24:27], s49 offen
    buffer_load_dwordx4 v[240:243], v10, s[24:27], s50 offen
    buffer_load_dwordx4 v[244:247], v10, s[24:27], s51 offen

    buffer_load_dwordx4 v[112:115], v4, s[20:23], s47 offen offset:0
    buffer_load_dwordx4 v[116:119], v4, s[20:23], s36 offen offset:0
    buffer_load_dwordx4 v[120:123], v4, s[20:23], s37 offen offset:0
    buffer_load_dwordx4 v[124:127], v4, s[16:19], s48 offen offset:0
    buffer_load_dwordx4 v[128:131], v4, s[16:19], s38 offen offset:0
    buffer_load_dwordx4 v[132:135], v4, s[20:23], s47 offen offset:128
    buffer_load_dwordx4 v[136:139], v4, s[20:23], s36 offen offset:128
    buffer_load_dwordx4 v[140:143], v4, s[20:23], s37 offen offset:128
    buffer_load_dwordx4 v[144:147], v4, s[16:19], s48 offen offset:128
    buffer_load_dwordx4 v[148:151], v4, s[16:19], s38 offen offset:128
    buffer_load_dwordx4 v[152:155], v4, s[20:23], s47 offen offset:256
    buffer_load_dwordx4 v[156:159], v4, s[20:23], s36 offen offset:256
    buffer_load_dwordx4 v[160:163], v4, s[20:23], s37 offen offset:256
    buffer_load_dwordx4 v[164:167], v4, s[16:19], s48 offen offset:256
    buffer_load_dwordx4 v[168:171], v4, s[16:19], s38 offen offset:256
    buffer_load_dwordx4 v[172:175], v4, s[20:23], s47 offen offset:384
    buffer_load_dwordx4 v[176:179], v4, s[20:23], s36 offen offset:384
    buffer_load_dwordx4 v[180:183], v4, s[20:23], s37 offen offset:384
    buffer_load_dwordx4 v[184:187], v4, s[16:19], s48 offen offset:384
    buffer_load_dwordx4 v[188:191], v4, s[16:19], s38 offen offset:384
    buffer_load_dwordx4 v[192:195], v4, s[20:23], s47 offen offset:512
    buffer_load_dwordx4 v[196:199], v4, s[20:23], s36 offen offset:512
    buffer_load_dwordx4 v[200:203], v4, s[20:23], s37 offen offset:512
    buffer_load_dwordx4 v[204:207], v4, s[16:19], s48 offen offset:512
    buffer_load_dwordx4 v[208:211], v4, s[16:19], s38 offen offset:512
    buffer_load_dwordx4 v[212:215], v4, s[20:23], s47 offen offset:640
    buffer_load_dwordx4 v[216:219], v4, s[20:23], s36 offen offset:640
    buffer_load_dwordx4 v[220:223], v4, s[20:23], s37 offen offset:640
    buffer_load_dwordx4 v[224:227], v4, s[16:19], s48 offen offset:640
    buffer_load_dwordx4 v[228:231], v4, s[16:19], s38 offen offset:640
    s_waitcnt vmcnt(25)
    ds_write_b128 v5, v[112:115] offset:0
    ds_write_b128 v5, v[116:119] offset:4608
    s_mov_b64 s[42:43], exec
    s_mov_b64 exec, s[40:41]
    ds_write_b128 v5, v[120:123] offset:9216
    s_mov_b64 exec, s[42:43]
    ds_write_b128 v5, v[124:127] offset:11520
    ds_write_b128 v5, v[128:131] offset:16128
    s_waitcnt vmcnt(20)
    ds_write_b128 v5, v[132:135] offset:20736
    ds_write_b128 v5, v[136:139] offset:25344
    s_mov_b64 s[42:43], exec
    s_mov_b64 exec, s[40:41]
    ds_write_b128 v5, v[140:143] offset:29952
    s_mov_b64 exec, s[42:43]
    ds_write_b128 v5, v[144:147] offset:32256
    ds_write_b128 v5, v[148:151] offset:36864
    buffer_load_dwordx4 v[112:115], v4, s[20:23], s47 offen offset:768
    buffer_load_dwordx4 v[116:119], v4, s[20:23], s36 offen offset:768
    buffer_load_dwordx4 v[120:123], v4, s[20:23], s37 offen offset:768
    buffer_load_dwordx4 v[124:127], v4, s[16:19], s48 offen offset:768
    buffer_load_dwordx4 v[128:131], v4, s[16:19], s38 offen offset:768
    s_waitcnt lgkmcnt(0)
    s_barrier
    ds_read_b128 v[56:59], v8 offset:0
    ds_read_b128 v[60:63], v8 offset:2304
    ds_read_b128 v[64:67], v8 offset:4608
    ds_read_b128 v[68:71], v8 offset:6912
    ds_read_b128 v[72:75], v8 offset:9216
    ds_read_b128 v[76:79], v9 offset:11520
    ds_read_b128 v[80:83], v9 offset:13824
    s_waitcnt vmcnt(20)
    ds_write_b128 v5, v[152:155] offset:41472
    ds_write_b128 v5, v[156:159] offset:46080
    s_mov_b64 s[42:43], exec
    s_mov_b64 exec, s[40:41]
    ds_write_b128 v5, v[160:163] offset:50688
    s_mov_b64 exec, s[42:43]
    ds_write_b128 v5, v[164:167] offset:52992
    ds_write_b128 v5, v[168:171] offset:57600
    buffer_load_dwordx4 v[132:135], v4, s[20:23], s47 offen offset:896
    buffer_load_dwordx4 v[136:139], v4, s[20:23], s36 offen offset:896
    buffer_load_dwordx4 v[140:143], v4, s[20:23], s37 offen offset:896
    buffer_load_dwordx4 v[144:147], v4, s[16:19], s48 offen offset:896
    buffer_load_dwordx4 v[148:151], v4, s[16:19], s38 offen offset:896
    s_waitcnt lgkmcnt(6)
    ds_read_b128 v[84:87], v8 offset:20736
    ds_read_b128 v[88:91], v8 offset:23040
    ds_read_b128 v[92:95], v8 offset:25344
    ds_read_b128 v[96:99], v8 offset:27648
    ds_read_b128 v[100:103], v8 offset:29952
    ds_read_b128 v[104:107], v9 offset:32256
    ds_read_b128 v[108:111], v9 offset:34560
    v_mfma_f32_16x16x32_bf16 v[16:19], v[56:59], v[76:79], v[16:19]
    v_mfma_f32_16x16x32_bf16 v[20:23], v[56:59], v[80:83], v[20:23]
    v_mfma_f32_16x16x32_bf16 v[24:27], v[60:63], v[76:79], v[24:27]
    v_mfma_f32_16x16x32_bf16 v[28:31], v[60:63], v[80:83], v[28:31]
    v_mfma_f32_16x16x32_bf16 v[32:35], v[64:67], v[76:79], v[32:35]
    v_mfma_f32_16x16x32_bf16 v[36:39], v[64:67], v[80:83], v[36:39]
    v_mfma_f32_16x16x32_bf16 v[40:43], v[68:71], v[76:79], v[40:43]
    v_mfma_f32_16x16x32_bf16 v[44:47], v[68:71], v[80:83], v[44:47]
    v_mfma_f32_16x16x32_bf16 v[48:51], v[72:75], v[76:79], v[48:51]
    v_mfma_f32_16x16x32_bf16 v[52:55], v[72:75], v[80:83], v[52:55]
    s_waitcnt lgkmcnt(7)
    s_barrier
    s_waitcnt vmcnt(20)
    ds_write_b128 v5, v[172:175] offset:0
    ds_write_b128 v5, v[176:179] offset:4608
    s_mov_b64 s[42:43], exec
    s_mov_b64 exec, s[40:41]
    ds_write_b128 v5, v[180:183] offset:9216
    s_mov_b64 exec, s[42:43]
    ds_write_b128 v5, v[184:187] offset:11520
    ds_write_b128 v5, v[188:191] offset:16128
    buffer_load_dwordx4 v[152:155], v4, s[20:23], s47 offen offset:1024
    buffer_load_dwordx4 v[156:159], v4, s[20:23], s36 offen offset:1024
    buffer_load_dwordx4 v[160:163], v4, s[20:23], s37 offen offset:1024
    buffer_load_dwordx4 v[164:167], v4, s[16:19], s48 offen offset:1024
    buffer_load_dwordx4 v[168:171], v4, s[16:19], s38 offen offset:1024
    s_waitcnt lgkmcnt(6)
    ds_read_b128 v[56:59], v8 offset:41472
    ds_read_b128 v[60:63], v8 offset:43776
    ds_read_b128 v[64:67], v8 offset:46080
    ds_read_b128 v[68:71], v8 offset:48384
    ds_read_b128 v[72:75], v8 offset:50688
    ds_read_b128 v[76:79], v9 offset:52992
    ds_read_b128 v[80:83], v9 offset:55296
    v_mfma_f32_16x16x32_bf16 v[16:19], v[84:87], v[104:107], v[16:19]
    v_mfma_f32_16x16x32_bf16 v[20:23], v[84:87], v[108:111], v[20:23]
    v_mfma_f32_16x16x32_bf16 v[24:27], v[88:91], v[104:107], v[24:27]
    v_mfma_f32_16x16x32_bf16 v[28:31], v[88:91], v[108:111], v[28:31]
    v_mfma_f32_16x16x32_bf16 v[32:35], v[92:95], v[104:107], v[32:35]
    v_mfma_f32_16x16x32_bf16 v[36:39], v[92:95], v[108:111], v[36:39]
    v_mfma_f32_16x16x32_bf16 v[40:43], v[96:99], v[104:107], v[40:43]
    v_mfma_f32_16x16x32_bf16 v[44:47], v[96:99], v[108:111], v[44:47]
    v_mfma_f32_16x16x32_bf16 v[48:51], v[100:103], v[104:107], v[48:51]
    v_mfma_f32_16x16x32_bf16 v[52:55], v[100:103], v[108:111], v[52:55]
    s_waitcnt lgkmcnt(7)
    s_barrier
    s_waitcnt vmcnt(20)
    ds_write_b128 v5, v[192:195] offset:20736
    ds_write_b128 v5, v[196:199] offset:25344
    s_mov_b64 s[42:43], exec
    s_mov_b64 exec, s[40:41]
    ds_write_b128 v5, v[200:203] offset:29952
    s_mov_b64 exec, s[42:43]
    ds_write_b128 v5, v[204:207] offset:32256
    ds_write_b128 v5, v[208:211] offset:36864
    buffer_load_dwordx4 v[172:175], v4, s[20:23], s47 offen offset:1152
    buffer_load_dwordx4 v[176:179], v4, s[20:23], s36 offen offset:1152
    buffer_load_dwordx4 v[180:183], v4, s[20:23], s37 offen offset:1152
    buffer_load_dwordx4 v[184:187], v4, s[16:19], s48 offen offset:1152
    buffer_load_dwordx4 v[188:191], v4, s[16:19], s38 offen offset:1152
    s_waitcnt lgkmcnt(6)
    ds_read_b128 v[84:87], v8 offset:0
    ds_read_b128 v[88:91], v8 offset:2304
    ds_read_b128 v[92:95], v8 offset:4608
    ds_read_b128 v[96:99], v8 offset:6912
    ds_read_b128 v[100:103], v8 offset:9216
    ds_read_b128 v[104:107], v9 offset:11520
    ds_read_b128 v[108:111], v9 offset:13824
    v_mfma_f32_16x16x32_bf16 v[16:19], v[56:59], v[76:79], v[16:19]
    v_mfma_f32_16x16x32_bf16 v[20:23], v[56:59], v[80:83], v[20:23]
    v_mfma_f32_16x16x32_bf16 v[24:27], v[60:63], v[76:79], v[24:27]
    v_mfma_f32_16x16x32_bf16 v[28:31], v[60:63], v[80:83], v[28:31]
    v_mfma_f32_16x16x32_bf16 v[32:35], v[64:67], v[76:79], v[32:35]
    v_mfma_f32_16x16x32_bf16 v[36:39], v[64:67], v[80:83], v[36:39]
    v_mfma_f32_16x16x32_bf16 v[40:43], v[68:71], v[76:79], v[40:43]
    v_mfma_f32_16x16x32_bf16 v[44:47], v[68:71], v[80:83], v[44:47]
    v_mfma_f32_16x16x32_bf16 v[48:51], v[72:75], v[76:79], v[48:51]
    v_mfma_f32_16x16x32_bf16 v[52:55], v[72:75], v[80:83], v[52:55]
    s_waitcnt lgkmcnt(7)
    s_barrier
    s_waitcnt vmcnt(20)
    ds_write_b128 v5, v[212:215] offset:41472
    ds_write_b128 v5, v[216:219] offset:46080
    s_mov_b64 s[42:43], exec
    s_mov_b64 exec, s[40:41]
    ds_write_b128 v5, v[220:223] offset:50688
    s_mov_b64 exec, s[42:43]
    ds_write_b128 v5, v[224:227] offset:52992
    ds_write_b128 v5, v[228:231] offset:57600
    buffer_load_dwordx4 v[192:195], v4, s[20:23], s47 offen offset:1280
    buffer_load_dwordx4 v[196:199], v4, s[20:23], s36 offen offset:1280
    buffer_load_dwordx4 v[200:203], v4, s[20:23], s37 offen offset:1280
    buffer_load_dwordx4 v[204:207], v4, s[16:19], s48 offen offset:1280
    buffer_load_dwordx4 v[208:211], v4, s[16:19], s38 offen offset:1280
    s_waitcnt lgkmcnt(6)
    ds_read_b128 v[56:59], v8 offset:20736
    ds_read_b128 v[60:63], v8 offset:23040
    ds_read_b128 v[64:67], v8 offset:25344
    ds_read_b128 v[68:71], v8 offset:27648
    ds_read_b128 v[72:75], v8 offset:29952
    ds_read_b128 v[76:79], v9 offset:32256
    ds_read_b128 v[80:83], v9 offset:34560
    v_mfma_f32_16x16x32_bf16 v[16:19], v[84:87], v[104:107], v[16:19]
    v_mfma_f32_16x16x32_bf16 v[20:23], v[84:87], v[108:111], v[20:23]
    v_mfma_f32_16x16x32_bf16 v[24:27], v[88:91], v[104:107], v[24:27]
    v_mfma_f32_16x16x32_bf16 v[28:31], v[88:91], v[108:111], v[28:31]
    v_mfma_f32_16x16x32_bf16 v[32:35], v[92:95], v[104:107], v[32:35]
    v_mfma_f32_16x16x32_bf16 v[36:39], v[92:95], v[108:111], v[36:39]
    v_mfma_f32_16x16x32_bf16 v[40:43], v[96:99], v[104:107], v[40:43]
    v_mfma_f32_16x16x32_bf16 v[44:47], v[96:99], v[108:111], v[44:47]
    v_mfma_f32_16x16x32_bf16 v[48:51], v[100:103], v[104:107], v[48:51]
    v_mfma_f32_16x16x32_bf16 v[52:55], v[100:103], v[108:111], v[52:55]
    s_waitcnt lgkmcnt(7)
    s_barrier
    s_waitcnt vmcnt(20)
    ds_write_b128 v5, v[112:115] offset:0
    ds_write_b128 v5, v[116:119] offset:4608
    s_mov_b64 s[42:43], exec
    s_mov_b64 exec, s[40:41]
    ds_write_b128 v5, v[120:123] offset:9216
    s_mov_b64 exec, s[42:43]
    ds_write_b128 v5, v[124:127] offset:11520
    ds_write_b128 v5, v[128:131] offset:16128
    buffer_load_dwordx4 v[212:215], v4, s[20:23], s47 offen offset:1408
    buffer_load_dwordx4 v[216:219], v4, s[20:23], s36 offen offset:1408
    buffer_load_dwordx4 v[220:223], v4, s[20:23], s37 offen offset:1408
    buffer_load_dwordx4 v[224:227], v4, s[16:19], s48 offen offset:1408
    buffer_load_dwordx4 v[228:231], v4, s[16:19], s38 offen offset:1408
    s_waitcnt lgkmcnt(6)
    ds_read_b128 v[84:87], v8 offset:41472
    ds_read_b128 v[88:91], v8 offset:43776
    ds_read_b128 v[92:95], v8 offset:46080
    ds_read_b128 v[96:99], v8 offset:48384
    ds_read_b128 v[100:103], v8 offset:50688
    ds_read_b128 v[104:107], v9 offset:52992
    ds_read_b128 v[108:111], v9 offset:55296
    v_mfma_f32_16x16x32_bf16 v[16:19], v[56:59], v[76:79], v[16:19]
    v_mfma_f32_16x16x32_bf16 v[20:23], v[56:59], v[80:83], v[20:23]
    v_mfma_f32_16x16x32_bf16 v[24:27], v[60:63], v[76:79], v[24:27]
    v_mfma_f32_16x16x32_bf16 v[28:31], v[60:63], v[80:83], v[28:31]
    v_mfma_f32_16x16x32_bf16 v[32:35], v[64:67], v[76:79], v[32:35]
    v_mfma_f32_16x16x32_bf16 v[36:39], v[64:67], v[80:83], v[36:39]
    v_mfma_f32_16x16x32_bf16 v[40:43], v[68:71], v[76:79], v[40:43]
    v_mfma_f32_16x16x32_bf16 v[44:47], v[68:71], v[80:83], v[44:47]
    v_mfma_f32_16x16x32_bf16 v[48:51], v[72:75], v[76:79], v[48:51]
    v_mfma_f32_16x16x32_bf16 v[52:55], v[72:75], v[80:83], v[52:55]
    s_waitcnt lgkmcnt(7)
    s_barrier
    s_waitcnt vmcnt(20)
    ds_write_b128 v5, v[132:135] offset:20736
    ds_write_b128 v5, v[136:139] offset:25344
    s_mov_b64 s[42:43], exec
    s_mov_b64 exec, s[40:41]
    ds_write_b128 v5, v[140:143] offset:29952
    s_mov_b64 exec, s[42:43]
    ds_write_b128 v5, v[144:147] offset:32256
    ds_write_b128 v5, v[148:151] offset:36864
    buffer_load_dwordx4 v[112:115], v4, s[20:23], s47 offen offset:1536
    buffer_load_dwordx4 v[116:119], v4, s[20:23], s36 offen offset:1536
    buffer_load_dwordx4 v[120:123], v4, s[20:23], s37 offen offset:1536
    buffer_load_dwordx4 v[124:127], v4, s[16:19], s48 offen offset:1536
    buffer_load_dwordx4 v[128:131], v4, s[16:19], s38 offen offset:1536
    s_waitcnt lgkmcnt(6)
    ds_read_b128 v[56:59], v8 offset:0
    ds_read_b128 v[60:63], v8 offset:2304
    ds_read_b128 v[64:67], v8 offset:4608
    ds_read_b128 v[68:71], v8 offset:6912
    ds_read_b128 v[72:75], v8 offset:9216
    ds_read_b128 v[76:79], v9 offset:11520
    ds_read_b128 v[80:83], v9 offset:13824
    v_mfma_f32_16x16x32_bf16 v[16:19], v[84:87], v[104:107], v[16:19]
    v_mfma_f32_16x16x32_bf16 v[20:23], v[84:87], v[108:111], v[20:23]
    v_mfma_f32_16x16x32_bf16 v[24:27], v[88:91], v[104:107], v[24:27]
    v_mfma_f32_16x16x32_bf16 v[28:31], v[88:91], v[108:111], v[28:31]
    v_mfma_f32_16x16x32_bf16 v[32:35], v[92:95], v[104:107], v[32:35]
    v_mfma_f32_16x16x32_bf16 v[36:39], v[92:95], v[108:111], v[36:39]
    v_mfma_f32_16x16x32_bf16 v[40:43], v[96:99], v[104:107], v[40:43]
    v_mfma_f32_16x16x32_bf16 v[44:47], v[96:99], v[108:111], v[44:47]
    v_mfma_f32_16x16x32_bf16 v[48:51], v[100:103], v[104:107], v[48:51]
    v_mfma_f32_16x16x32_bf16 v[52:55], v[100:103], v[108:111], v[52:55]
    s_waitcnt lgkmcnt(7)
    s_barrier
    s_waitcnt vmcnt(20)
    ds_write_b128 v5, v[152:155] offset:41472
    ds_write_b128 v5, v[156:159] offset:46080
    s_mov_b64 s[42:43], exec
    s_mov_b64 exec, s[40:41]
    ds_write_b128 v5, v[160:163] offset:50688
    s_mov_b64 exec, s[42:43]
    ds_write_b128 v5, v[164:167] offset:52992
    ds_write_b128 v5, v[168:171] offset:57600
    buffer_load_dwordx4 v[132:135], v4, s[20:23], s47 offen offset:1664
    buffer_load_dwordx4 v[136:139], v4, s[20:23], s36 offen offset:1664
    buffer_load_dwordx4 v[140:143], v4, s[20:23], s37 offen offset:1664
    buffer_load_dwordx4 v[144:147], v4, s[16:19], s48 offen offset:1664
    buffer_load_dwordx4 v[148:151], v4, s[16:19], s38 offen offset:1664
    s_waitcnt lgkmcnt(6)
    ds_read_b128 v[84:87], v8 offset:20736
    ds_read_b128 v[88:91], v8 offset:23040
    ds_read_b128 v[92:95], v8 offset:25344
    ds_read_b128 v[96:99], v8 offset:27648
    ds_read_b128 v[100:103], v8 offset:29952
    ds_read_b128 v[104:107], v9 offset:32256
    ds_read_b128 v[108:111], v9 offset:34560
    v_mfma_f32_16x16x32_bf16 v[16:19], v[56:59], v[76:79], v[16:19]
    v_mfma_f32_16x16x32_bf16 v[20:23], v[56:59], v[80:83], v[20:23]
    v_mfma_f32_16x16x32_bf16 v[24:27], v[60:63], v[76:79], v[24:27]
    v_mfma_f32_16x16x32_bf16 v[28:31], v[60:63], v[80:83], v[28:31]
    v_mfma_f32_16x16x32_bf16 v[32:35], v[64:67], v[76:79], v[32:35]
    v_mfma_f32_16x16x32_bf16 v[36:39], v[64:67], v[80:83], v[36:39]
    v_mfma_f32_16x16x32_bf16 v[40:43], v[68:71], v[76:79], v[40:43]
    v_mfma_f32_16x16x32_bf16 v[44:47], v[68:71], v[80:83], v[44:47]
    v_mfma_f32_16x16x32_bf16 v[48:51], v[72:75], v[76:79], v[48:51]
    v_mfma_f32_16x16x32_bf16 v[52:55], v[72:75], v[80:83], v[52:55]
    s_waitcnt lgkmcnt(7)
    s_barrier
    s_waitcnt vmcnt(20)
    ds_write_b128 v5, v[172:175] offset:0
    ds_write_b128 v5, v[176:179] offset:4608
    s_mov_b64 s[42:43], exec
    s_mov_b64 exec, s[40:41]
    ds_write_b128 v5, v[180:183] offset:9216
    s_mov_b64 exec, s[42:43]
    ds_write_b128 v5, v[184:187] offset:11520
    ds_write_b128 v5, v[188:191] offset:16128
    buffer_load_dwordx4 v[152:155], v4, s[20:23], s47 offen offset:1792
    buffer_load_dwordx4 v[156:159], v4, s[20:23], s36 offen offset:1792
    buffer_load_dwordx4 v[160:163], v4, s[20:23], s37 offen offset:1792
    buffer_load_dwordx4 v[164:167], v4, s[16:19], s48 offen offset:1792
    buffer_load_dwordx4 v[168:171], v4, s[16:19], s38 offen offset:1792
    s_waitcnt lgkmcnt(6)
    ds_read_b128 v[56:59], v8 offset:41472
    ds_read_b128 v[60:63], v8 offset:43776
    ds_read_b128 v[64:67], v8 offset:46080
    ds_read_b128 v[68:71], v8 offset:48384
    ds_read_b128 v[72:75], v8 offset:50688
    ds_read_b128 v[76:79], v9 offset:52992
    ds_read_b128 v[80:83], v9 offset:55296
    v_mfma_f32_16x16x32_bf16 v[16:19], v[84:87], v[104:107], v[16:19]
    v_mfma_f32_16x16x32_bf16 v[20:23], v[84:87], v[108:111], v[20:23]
    v_mfma_f32_16x16x32_bf16 v[24:27], v[88:91], v[104:107], v[24:27]
    v_mfma_f32_16x16x32_bf16 v[28:31], v[88:91], v[108:111], v[28:31]
    v_mfma_f32_16x16x32_bf16 v[32:35], v[92:95], v[104:107], v[32:35]
    v_mfma_f32_16x16x32_bf16 v[36:39], v[92:95], v[108:111], v[36:39]
    v_mfma_f32_16x16x32_bf16 v[40:43], v[96:99], v[104:107], v[40:43]
    v_mfma_f32_16x16x32_bf16 v[44:47], v[96:99], v[108:111], v[44:47]
    v_mfma_f32_16x16x32_bf16 v[48:51], v[100:103], v[104:107], v[48:51]
    v_mfma_f32_16x16x32_bf16 v[52:55], v[100:103], v[108:111], v[52:55]
    s_waitcnt lgkmcnt(7)
    s_barrier
    s_waitcnt vmcnt(20)
    ds_write_b128 v5, v[192:195] offset:20736
    ds_write_b128 v5, v[196:199] offset:25344
    s_mov_b64 s[42:43], exec
    s_mov_b64 exec, s[40:41]
    ds_write_b128 v5, v[200:203] offset:29952
    s_mov_b64 exec, s[42:43]
    ds_write_b128 v5, v[204:207] offset:32256
    ds_write_b128 v5, v[208:211] offset:36864
    buffer_load_dwordx4 v[172:175], v4, s[20:23], s47 offen offset:1920
    buffer_load_dwordx4 v[176:179], v4, s[20:23], s36 offen offset:1920
    buffer_load_dwordx4 v[180:183], v4, s[20:23], s37 offen offset:1920
    buffer_load_dwordx4 v[184:187], v4, s[16:19], s48 offen offset:1920
    buffer_load_dwordx4 v[188:191], v4, s[16:19], s38 offen offset:1920
    s_waitcnt lgkmcnt(6)
    ds_read_b128 v[84:87], v8 offset:0
    ds_read_b128 v[88:91], v8 offset:2304
    ds_read_b128 v[92:95], v8 offset:4608
    ds_read_b128 v[96:99], v8 offset:6912
    ds_read_b128 v[100:103], v8 offset:9216
    ds_read_b128 v[104:107], v9 offset:11520
    ds_read_b128 v[108:111], v9 offset:13824
    v_mfma_f32_16x16x32_bf16 v[16:19], v[56:59], v[76:79], v[16:19]
    v_mfma_f32_16x16x32_bf16 v[20:23], v[56:59], v[80:83], v[20:23]
    v_mfma_f32_16x16x32_bf16 v[24:27], v[60:63], v[76:79], v[24:27]
    v_mfma_f32_16x16x32_bf16 v[28:31], v[60:63], v[80:83], v[28:31]
    v_mfma_f32_16x16x32_bf16 v[32:35], v[64:67], v[76:79], v[32:35]
    v_mfma_f32_16x16x32_bf16 v[36:39], v[64:67], v[80:83], v[36:39]
    v_mfma_f32_16x16x32_bf16 v[40:43], v[68:71], v[76:79], v[40:43]
    v_mfma_f32_16x16x32_bf16 v[44:47], v[68:71], v[80:83], v[44:47]
    v_mfma_f32_16x16x32_bf16 v[48:51], v[72:75], v[76:79], v[48:51]
    v_mfma_f32_16x16x32_bf16 v[52:55], v[72:75], v[80:83], v[52:55]
    s_waitcnt lgkmcnt(7)
    s_barrier
    s_waitcnt vmcnt(20)
    ds_write_b128 v5, v[212:215] offset:41472
    ds_write_b128 v5, v[216:219] offset:46080
    s_mov_b64 s[42:43], exec
    s_mov_b64 exec, s[40:41]
    ds_write_b128 v5, v[220:223] offset:50688
    s_mov_b64 exec, s[42:43]
    ds_write_b128 v5, v[224:227] offset:52992
    ds_write_b128 v5, v[228:231] offset:57600
    buffer_load_dwordx4 v[192:195], v4, s[20:23], s47 offen offset:2048
    buffer_load_dwordx4 v[196:199], v4, s[20:23], s36 offen offset:2048
    buffer_load_dwordx4 v[200:203], v4, s[20:23], s37 offen offset:2048
    buffer_load_dwordx4 v[204:207], v4, s[16:19], s48 offen offset:2048
    buffer_load_dwordx4 v[208:211], v4, s[16:19], s38 offen offset:2048
    s_waitcnt lgkmcnt(6)
    ds_read_b128 v[56:59], v8 offset:20736
    ds_read_b128 v[60:63], v8 offset:23040
    ds_read_b128 v[64:67], v8 offset:25344
    ds_read_b128 v[68:71], v8 offset:27648
    ds_read_b128 v[72:75], v8 offset:29952
    ds_read_b128 v[76:79], v9 offset:32256
    ds_read_b128 v[80:83], v9 offset:34560
    v_mfma_f32_16x16x32_bf16 v[16:19], v[84:87], v[104:107], v[16:19]
    v_mfma_f32_16x16x32_bf16 v[20:23], v[84:87], v[108:111], v[20:23]
    v_mfma_f32_16x16x32_bf16 v[24:27], v[88:91], v[104:107], v[24:27]
    v_mfma_f32_16x16x32_bf16 v[28:31], v[88:91], v[108:111], v[28:31]
    v_mfma_f32_16x16x32_bf16 v[32:35], v[92:95], v[104:107], v[32:35]
    v_mfma_f32_16x16x32_bf16 v[36:39], v[92:95], v[108:111], v[36:39]
    v_mfma_f32_16x16x32_bf16 v[40:43], v[96:99], v[104:107], v[40:43]
    v_mfma_f32_16x16x32_bf16 v[44:47], v[96:99], v[108:111], v[44:47]
    v_mfma_f32_16x16x32_bf16 v[48:51], v[100:103], v[104:107], v[48:51]
    v_mfma_f32_16x16x32_bf16 v[52:55], v[100:103], v[108:111], v[52:55]
    s_waitcnt lgkmcnt(7)
    s_barrier
    s_waitcnt vmcnt(20)
    ds_write_b128 v5, v[112:115] offset:0
    ds_write_b128 v5, v[116:119] offset:4608
    s_mov_b64 s[42:43], exec
    s_mov_b64 exec, s[40:41]
    ds_write_b128 v5, v[120:123] offset:9216
    s_mov_b64 exec, s[42:43]
    ds_write_b128 v5, v[124:127] offset:11520
    ds_write_b128 v5, v[128:131] offset:16128
    buffer_load_dwordx4 v[212:215], v4, s[20:23], s47 offen offset:2176
    buffer_load_dwordx4 v[216:219], v4, s[20:23], s36 offen offset:2176
    buffer_load_dwordx4 v[220:223], v4, s[20:23], s37 offen offset:2176
    buffer_load_dwordx4 v[224:227], v4, s[16:19], s48 offen offset:2176
    buffer_load_dwordx4 v[228:231], v4, s[16:19], s38 offen offset:2176
    s_waitcnt lgkmcnt(6)
    ds_read_b128 v[84:87], v8 offset:41472
    ds_read_b128 v[88:91], v8 offset:43776
    ds_read_b128 v[92:95], v8 offset:46080
    ds_read_b128 v[96:99], v8 offset:48384
    ds_read_b128 v[100:103], v8 offset:50688
    ds_read_b128 v[104:107], v9 offset:52992
    ds_read_b128 v[108:111], v9 offset:55296
    v_mfma_f32_16x16x32_bf16 v[16:19], v[56:59], v[76:79], v[16:19]
    v_mfma_f32_16x16x32_bf16 v[20:23], v[56:59], v[80:83], v[20:23]
    v_mfma_f32_16x16x32_bf16 v[24:27], v[60:63], v[76:79], v[24:27]
    v_mfma_f32_16x16x32_bf16 v[28:31], v[60:63], v[80:83], v[28:31]
    v_mfma_f32_16x16x32_bf16 v[32:35], v[64:67], v[76:79], v[32:35]
    v_mfma_f32_16x16x32_bf16 v[36:39], v[64:67], v[80:83], v[36:39]
    v_mfma_f32_16x16x32_bf16 v[40:43], v[68:71], v[76:79], v[40:43]
    v_mfma_f32_16x16x32_bf16 v[44:47], v[68:71], v[80:83], v[44:47]
    v_mfma_f32_16x16x32_bf16 v[48:51], v[72:75], v[76:79], v[48:51]
    v_mfma_f32_16x16x32_bf16 v[52:55], v[72:75], v[80:83], v[52:55]
    s_waitcnt lgkmcnt(7)
    s_barrier
    s_waitcnt vmcnt(20)
    ds_write_b128 v5, v[132:135] offset:20736
    ds_write_b128 v5, v[136:139] offset:25344
    s_mov_b64 s[42:43], exec
    s_mov_b64 exec, s[40:41]
    ds_write_b128 v5, v[140:143] offset:29952
    s_mov_b64 exec, s[42:43]
    ds_write_b128 v5, v[144:147] offset:32256
    ds_write_b128 v5, v[148:151] offset:36864
    buffer_load_dwordx4 v[112:115], v4, s[20:23], s47 offen offset:2304
    buffer_load_dwordx4 v[116:119], v4, s[20:23], s36 offen offset:2304
    buffer_load_dwordx4 v[120:123], v4, s[20:23], s37 offen offset:2304
    buffer_load_dwordx4 v[124:127], v4, s[16:19], s48 offen offset:2304
    buffer_load_dwordx4 v[128:131], v4, s[16:19], s38 offen offset:2304
    s_waitcnt lgkmcnt(6)
    ds_read_b128 v[56:59], v8 offset:0
    ds_read_b128 v[60:63], v8 offset:2304
    ds_read_b128 v[64:67], v8 offset:4608
    ds_read_b128 v[68:71], v8 offset:6912
    ds_read_b128 v[72:75], v8 offset:9216
    ds_read_b128 v[76:79], v9 offset:11520
    ds_read_b128 v[80:83], v9 offset:13824
    v_mfma_f32_16x16x32_bf16 v[16:19], v[84:87], v[104:107], v[16:19]
    v_mfma_f32_16x16x32_bf16 v[20:23], v[84:87], v[108:111], v[20:23]
    v_mfma_f32_16x16x32_bf16 v[24:27], v[88:91], v[104:107], v[24:27]
    v_mfma_f32_16x16x32_bf16 v[28:31], v[88:91], v[108:111], v[28:31]
    v_mfma_f32_16x16x32_bf16 v[32:35], v[92:95], v[104:107], v[32:35]
    v_mfma_f32_16x16x32_bf16 v[36:39], v[92:95], v[108:111], v[36:39]
    v_mfma_f32_16x16x32_bf16 v[40:43], v[96:99], v[104:107], v[40:43]
    v_mfma_f32_16x16x32_bf16 v[44:47], v[96:99], v[108:111], v[44:47]
    v_mfma_f32_16x16x32_bf16 v[48:51], v[100:103], v[104:107], v[48:51]
    v_mfma_f32_16x16x32_bf16 v[52:55], v[100:103], v[108:111], v[52:55]
    s_waitcnt lgkmcnt(7)
    s_barrier
    s_waitcnt vmcnt(20)
    ds_write_b128 v5, v[152:155] offset:41472
    ds_write_b128 v5, v[156:159] offset:46080
    s_mov_b64 s[42:43], exec
    s_mov_b64 exec, s[40:41]
    ds_write_b128 v5, v[160:163] offset:50688
    s_mov_b64 exec, s[42:43]
    ds_write_b128 v5, v[164:167] offset:52992
    ds_write_b128 v5, v[168:171] offset:57600
    buffer_load_dwordx4 v[132:135], v4, s[20:23], s47 offen offset:2432
    buffer_load_dwordx4 v[136:139], v4, s[20:23], s36 offen offset:2432
    buffer_load_dwordx4 v[140:143], v4, s[20:23], s37 offen offset:2432
    buffer_load_dwordx4 v[144:147], v4, s[16:19], s48 offen offset:2432
    buffer_load_dwordx4 v[148:151], v4, s[16:19], s38 offen offset:2432
    s_waitcnt lgkmcnt(6)
    ds_read_b128 v[84:87], v8 offset:20736
    ds_read_b128 v[88:91], v8 offset:23040
    ds_read_b128 v[92:95], v8 offset:25344
    ds_read_b128 v[96:99], v8 offset:27648
    ds_read_b128 v[100:103], v8 offset:29952
    ds_read_b128 v[104:107], v9 offset:32256
    ds_read_b128 v[108:111], v9 offset:34560
    v_mfma_f32_16x16x32_bf16 v[16:19], v[56:59], v[76:79], v[16:19]
    v_mfma_f32_16x16x32_bf16 v[20:23], v[56:59], v[80:83], v[20:23]
    v_mfma_f32_16x16x32_bf16 v[24:27], v[60:63], v[76:79], v[24:27]
    v_mfma_f32_16x16x32_bf16 v[28:31], v[60:63], v[80:83], v[28:31]
    v_mfma_f32_16x16x32_bf16 v[32:35], v[64:67], v[76:79], v[32:35]
    v_mfma_f32_16x16x32_bf16 v[36:39], v[64:67], v[80:83], v[36:39]
    v_mfma_f32_16x16x32_bf16 v[40:43], v[68:71], v[76:79], v[40:43]
    v_mfma_f32_16x16x32_bf16 v[44:47], v[68:71], v[80:83], v[44:47]
    v_mfma_f32_16x16x32_bf16 v[48:51], v[72:75], v[76:79], v[48:51]
    v_mfma_f32_16x16x32_bf16 v[52:55], v[72:75], v[80:83], v[52:55]
    s_waitcnt lgkmcnt(7)
    s_barrier
    s_waitcnt vmcnt(20)
    ds_write_b128 v5, v[172:175] offset:0
    ds_write_b128 v5, v[176:179] offset:4608
    s_mov_b64 s[42:43], exec
    s_mov_b64 exec, s[40:41]
    ds_write_b128 v5, v[180:183] offset:9216
    s_mov_b64 exec, s[42:43]
    ds_write_b128 v5, v[184:187] offset:11520
    ds_write_b128 v5, v[188:191] offset:16128
    buffer_load_dwordx4 v[152:155], v4, s[20:23], s47 offen offset:2560
    buffer_load_dwordx4 v[156:159], v4, s[20:23], s36 offen offset:2560
    buffer_load_dwordx4 v[160:163], v4, s[20:23], s37 offen offset:2560
    buffer_load_dwordx4 v[164:167], v4, s[16:19], s48 offen offset:2560
    buffer_load_dwordx4 v[168:171], v4, s[16:19], s38 offen offset:2560
    s_waitcnt lgkmcnt(6)
    ds_read_b128 v[56:59], v8 offset:41472
    ds_read_b128 v[60:63], v8 offset:43776
    ds_read_b128 v[64:67], v8 offset:46080
    ds_read_b128 v[68:71], v8 offset:48384
    ds_read_b128 v[72:75], v8 offset:50688
    ds_read_b128 v[76:79], v9 offset:52992
    ds_read_b128 v[80:83], v9 offset:55296
    v_mfma_f32_16x16x32_bf16 v[16:19], v[84:87], v[104:107], v[16:19]
    v_mfma_f32_16x16x32_bf16 v[20:23], v[84:87], v[108:111], v[20:23]
    v_mfma_f32_16x16x32_bf16 v[24:27], v[88:91], v[104:107], v[24:27]
    v_mfma_f32_16x16x32_bf16 v[28:31], v[88:91], v[108:111], v[28:31]
    v_mfma_f32_16x16x32_bf16 v[32:35], v[92:95], v[104:107], v[32:35]
    v_mfma_f32_16x16x32_bf16 v[36:39], v[92:95], v[108:111], v[36:39]
    v_mfma_f32_16x16x32_bf16 v[40:43], v[96:99], v[104:107], v[40:43]
    v_mfma_f32_16x16x32_bf16 v[44:47], v[96:99], v[108:111], v[44:47]
    v_mfma_f32_16x16x32_bf16 v[48:51], v[100:103], v[104:107], v[48:51]
    v_mfma_f32_16x16x32_bf16 v[52:55], v[100:103], v[108:111], v[52:55]
    s_waitcnt lgkmcnt(7)
    s_barrier
    s_waitcnt vmcnt(20)
    ds_write_b128 v5, v[192:195] offset:20736
    ds_write_b128 v5, v[196:199] offset:25344
    s_mov_b64 s[42:43], exec
    s_mov_b64 exec, s[40:41]
    ds_write_b128 v5, v[200:203] offset:29952
    s_mov_b64 exec, s[42:43]
    ds_write_b128 v5, v[204:207] offset:32256
    ds_write_b128 v5, v[208:211] offset:36864
    buffer_load_dwordx4 v[172:175], v4, s[20:23], s47 offen offset:2688
    buffer_load_dwordx4 v[176:179], v4, s[20:23], s36 offen offset:2688
    buffer_load_dwordx4 v[180:183], v4, s[20:23], s37 offen offset:2688
    buffer_load_dwordx4 v[184:187], v4, s[16:19], s48 offen offset:2688
    buffer_load_dwordx4 v[188:191], v4, s[16:19], s38 offen offset:2688
    s_waitcnt lgkmcnt(6)
    ds_read_b128 v[84:87], v8 offset:0
    ds_read_b128 v[88:91], v8 offset:2304
    ds_read_b128 v[92:95], v8 offset:4608
    ds_read_b128 v[96:99], v8 offset:6912
    ds_read_b128 v[100:103], v8 offset:9216
    ds_read_b128 v[104:107], v9 offset:11520
    ds_read_b128 v[108:111], v9 offset:13824
    v_mfma_f32_16x16x32_bf16 v[16:19], v[56:59], v[76:79], v[16:19]
    v_mfma_f32_16x16x32_bf16 v[20:23], v[56:59], v[80:83], v[20:23]
    v_mfma_f32_16x16x32_bf16 v[24:27], v[60:63], v[76:79], v[24:27]
    v_mfma_f32_16x16x32_bf16 v[28:31], v[60:63], v[80:83], v[28:31]
    v_mfma_f32_16x16x32_bf16 v[32:35], v[64:67], v[76:79], v[32:35]
    v_mfma_f32_16x16x32_bf16 v[36:39], v[64:67], v[80:83], v[36:39]
    v_mfma_f32_16x16x32_bf16 v[40:43], v[68:71], v[76:79], v[40:43]
    v_mfma_f32_16x16x32_bf16 v[44:47], v[68:71], v[80:83], v[44:47]
    v_mfma_f32_16x16x32_bf16 v[48:51], v[72:75], v[76:79], v[48:51]
    v_mfma_f32_16x16x32_bf16 v[52:55], v[72:75], v[80:83], v[52:55]
    s_waitcnt lgkmcnt(7)
    s_barrier
    s_waitcnt vmcnt(20)
    ds_write_b128 v5, v[212:215] offset:41472
    ds_write_b128 v5, v[216:219] offset:46080
    s_mov_b64 s[42:43], exec
    s_mov_b64 exec, s[40:41]
    ds_write_b128 v5, v[220:223] offset:50688
    s_mov_b64 exec, s[42:43]
    ds_write_b128 v5, v[224:227] offset:52992
    ds_write_b128 v5, v[228:231] offset:57600
    buffer_load_dwordx4 v[192:195], v4, s[20:23], s47 offen offset:2816
    buffer_load_dwordx4 v[196:199], v4, s[20:23], s36 offen offset:2816
    buffer_load_dwordx4 v[200:203], v4, s[20:23], s37 offen offset:2816
    buffer_load_dwordx4 v[204:207], v4, s[16:19], s48 offen offset:2816
    buffer_load_dwordx4 v[208:211], v4, s[16:19], s38 offen offset:2816
    s_waitcnt lgkmcnt(6)
    ds_read_b128 v[56:59], v8 offset:20736
    ds_read_b128 v[60:63], v8 offset:23040
    ds_read_b128 v[64:67], v8 offset:25344
    ds_read_b128 v[68:71], v8 offset:27648
    ds_read_b128 v[72:75], v8 offset:29952
    ds_read_b128 v[76:79], v9 offset:32256
    ds_read_b128 v[80:83], v9 offset:34560
    v_mfma_f32_16x16x32_bf16 v[16:19], v[84:87], v[104:107], v[16:19]
    v_mfma_f32_16x16x32_bf16 v[20:23], v[84:87], v[108:111], v[20:23]
    v_mfma_f32_16x16x32_bf16 v[24:27], v[88:91], v[104:107], v[24:27]
    v_mfma_f32_16x16x32_bf16 v[28:31], v[88:91], v[108:111], v[28:31]
    v_mfma_f32_16x16x32_bf16 v[32:35], v[92:95], v[104:107], v[32:35]
    v_mfma_f32_16x16x32_bf16 v[36:39], v[92:95], v[108:111], v[36:39]
    v_mfma_f32_16x16x32_bf16 v[40:43], v[96:99], v[104:107], v[40:43]
    v_mfma_f32_16x16x32_bf16 v[44:47], v[96:99], v[108:111], v[44:47]
    v_mfma_f32_16x16x32_bf16 v[48:51], v[100:103], v[104:107], v[48:51]
    v_mfma_f32_16x16x32_bf16 v[52:55], v[100:103], v[108:111], v[52:55]
    s_waitcnt lgkmcnt(7)
    s_barrier
    s_waitcnt vmcnt(20)
    ds_write_b128 v5, v[112:115] offset:0
    ds_write_b128 v5, v[116:119] offset:4608
    s_mov_b64 s[42:43], exec
    s_mov_b64 exec, s[40:41]
    ds_write_b128 v5, v[120:123] offset:9216
    s_mov_b64 exec, s[42:43]
    ds_write_b128 v5, v[124:127] offset:11520
    ds_write_b128 v5, v[128:131] offset:16128
    buffer_load_dwordx4 v[212:215], v4, s[20:23], s47 offen offset:2944
    buffer_load_dwordx4 v[216:219], v4, s[20:23], s36 offen offset:2944
    buffer_load_dwordx4 v[220:223], v4, s[20:23], s37 offen offset:2944
    buffer_load_dwordx4 v[224:227], v4, s[16:19], s48 offen offset:2944
    buffer_load_dwordx4 v[228:231], v4, s[16:19], s38 offen offset:2944
    s_waitcnt lgkmcnt(6)
    ds_read_b128 v[84:87], v8 offset:41472
    ds_read_b128 v[88:91], v8 offset:43776
    ds_read_b128 v[92:95], v8 offset:46080
    ds_read_b128 v[96:99], v8 offset:48384
    ds_read_b128 v[100:103], v8 offset:50688
    ds_read_b128 v[104:107], v9 offset:52992
    ds_read_b128 v[108:111], v9 offset:55296
    v_mfma_f32_16x16x32_bf16 v[16:19], v[56:59], v[76:79], v[16:19]
    v_mfma_f32_16x16x32_bf16 v[20:23], v[56:59], v[80:83], v[20:23]
    v_mfma_f32_16x16x32_bf16 v[24:27], v[60:63], v[76:79], v[24:27]
    v_mfma_f32_16x16x32_bf16 v[28:31], v[60:63], v[80:83], v[28:31]
    v_mfma_f32_16x16x32_bf16 v[32:35], v[64:67], v[76:79], v[32:35]
    v_mfma_f32_16x16x32_bf16 v[36:39], v[64:67], v[80:83], v[36:39]
    v_mfma_f32_16x16x32_bf16 v[40:43], v[68:71], v[76:79], v[40:43]
    v_mfma_f32_16x16x32_bf16 v[44:47], v[68:71], v[80:83], v[44:47]
    v_mfma_f32_16x16x32_bf16 v[48:51], v[72:75], v[76:79], v[48:51]
    v_mfma_f32_16x16x32_bf16 v[52:55], v[72:75], v[80:83], v[52:55]
    s_waitcnt lgkmcnt(7)
    s_barrier
    s_waitcnt vmcnt(20)
    ds_write_b128 v5, v[132:135] offset:20736
    ds_write_b128 v5, v[136:139] offset:25344
    s_mov_b64 s[42:43], exec
    s_mov_b64 exec, s[40:41]
    ds_write_b128 v5, v[140:143] offset:29952
    s_mov_b64 exec, s[42:43]
    ds_write_b128 v5, v[144:147] offset:32256
    ds_write_b128 v5, v[148:151] offset:36864
    buffer_load_dwordx4 v[112:115], v4, s[20:23], s47 offen offset:3072
    buffer_load_dwordx4 v[116:119], v4, s[20:23], s36 offen offset:3072
    buffer_load_dwordx4 v[120:123], v4, s[20:23], s37 offen offset:3072
    buffer_load_dwordx4 v[124:127], v4, s[16:19], s48 offen offset:3072
    buffer_load_dwordx4 v[128:131], v4, s[16:19], s38 offen offset:3072
    s_waitcnt lgkmcnt(6)
    ds_read_b128 v[56:59], v8 offset:0
    ds_read_b128 v[60:63], v8 offset:2304
    ds_read_b128 v[64:67], v8 offset:4608
    ds_read_b128 v[68:71], v8 offset:6912
    ds_read_b128 v[72:75], v8 offset:9216
    ds_read_b128 v[76:79], v9 offset:11520
    ds_read_b128 v[80:83], v9 offset:13824
    v_mfma_f32_16x16x32_bf16 v[16:19], v[84:87], v[104:107], v[16:19]
    v_mfma_f32_16x16x32_bf16 v[20:23], v[84:87], v[108:111], v[20:23]
    v_mfma_f32_16x16x32_bf16 v[24:27], v[88:91], v[104:107], v[24:27]
    v_mfma_f32_16x16x32_bf16 v[28:31], v[88:91], v[108:111], v[28:31]
    v_mfma_f32_16x16x32_bf16 v[32:35], v[92:95], v[104:107], v[32:35]
    v_mfma_f32_16x16x32_bf16 v[36:39], v[92:95], v[108:111], v[36:39]
    v_mfma_f32_16x16x32_bf16 v[40:43], v[96:99], v[104:107], v[40:43]
    v_mfma_f32_16x16x32_bf16 v[44:47], v[96:99], v[108:111], v[44:47]
    v_mfma_f32_16x16x32_bf16 v[48:51], v[100:103], v[104:107], v[48:51]
    v_mfma_f32_16x16x32_bf16 v[52:55], v[100:103], v[108:111], v[52:55]
    s_waitcnt lgkmcnt(7)
    s_barrier
    s_waitcnt vmcnt(20)
    ds_write_b128 v5, v[152:155] offset:41472
    ds_write_b128 v5, v[156:159] offset:46080
    s_mov_b64 s[42:43], exec
    s_mov_b64 exec, s[40:41]
    ds_write_b128 v5, v[160:163] offset:50688
    s_mov_b64 exec, s[42:43]
    ds_write_b128 v5, v[164:167] offset:52992
    ds_write_b128 v5, v[168:171] offset:57600
    buffer_load_dwordx4 v[132:135], v4, s[20:23], s47 offen offset:3200
    buffer_load_dwordx4 v[136:139], v4, s[20:23], s36 offen offset:3200
    buffer_load_dwordx4 v[140:143], v4, s[20:23], s37 offen offset:3200
    buffer_load_dwordx4 v[144:147], v4, s[16:19], s48 offen offset:3200
    buffer_load_dwordx4 v[148:151], v4, s[16:19], s38 offen offset:3200
    s_waitcnt lgkmcnt(6)
    ds_read_b128 v[84:87], v8 offset:20736
    ds_read_b128 v[88:91], v8 offset:23040
    ds_read_b128 v[92:95], v8 offset:25344
    ds_read_b128 v[96:99], v8 offset:27648
    ds_read_b128 v[100:103], v8 offset:29952
    ds_read_b128 v[104:107], v9 offset:32256
    ds_read_b128 v[108:111], v9 offset:34560
    v_mfma_f32_16x16x32_bf16 v[16:19], v[56:59], v[76:79], v[16:19]
    v_mfma_f32_16x16x32_bf16 v[20:23], v[56:59], v[80:83], v[20:23]
    v_mfma_f32_16x16x32_bf16 v[24:27], v[60:63], v[76:79], v[24:27]
    v_mfma_f32_16x16x32_bf16 v[28:31], v[60:63], v[80:83], v[28:31]
    v_mfma_f32_16x16x32_bf16 v[32:35], v[64:67], v[76:79], v[32:35]
    v_mfma_f32_16x16x32_bf16 v[36:39], v[64:67], v[80:83], v[36:39]
    v_mfma_f32_16x16x32_bf16 v[40:43], v[68:71], v[76:79], v[40:43]
    v_mfma_f32_16x16x32_bf16 v[44:47], v[68:71], v[80:83], v[44:47]
    v_mfma_f32_16x16x32_bf16 v[48:51], v[72:75], v[76:79], v[48:51]
    v_mfma_f32_16x16x32_bf16 v[52:55], v[72:75], v[80:83], v[52:55]
    s_waitcnt lgkmcnt(7)
    s_barrier
    s_waitcnt vmcnt(20)
    ds_write_b128 v5, v[172:175] offset:0
    ds_write_b128 v5, v[176:179] offset:4608
    s_mov_b64 s[42:43], exec
    s_mov_b64 exec, s[40:41]
    ds_write_b128 v5, v[180:183] offset:9216
    s_mov_b64 exec, s[42:43]
    ds_write_b128 v5, v[184:187] offset:11520
    ds_write_b128 v5, v[188:191] offset:16128
    buffer_load_dwordx4 v[152:155], v4, s[20:23], s47 offen offset:3328
    buffer_load_dwordx4 v[156:159], v4, s[20:23], s36 offen offset:3328
    buffer_load_dwordx4 v[160:163], v4, s[20:23], s37 offen offset:3328
    buffer_load_dwordx4 v[164:167], v4, s[16:19], s48 offen offset:3328
    buffer_load_dwordx4 v[168:171], v4, s[16:19], s38 offen offset:3328
    s_waitcnt lgkmcnt(6)
    ds_read_b128 v[56:59], v8 offset:41472
    ds_read_b128 v[60:63], v8 offset:43776
    ds_read_b128 v[64:67], v8 offset:46080
    ds_read_b128 v[68:71], v8 offset:48384
    ds_read_b128 v[72:75], v8 offset:50688
    ds_read_b128 v[76:79], v9 offset:52992
    ds_read_b128 v[80:83], v9 offset:55296
    v_mfma_f32_16x16x32_bf16 v[16:19], v[84:87], v[104:107], v[16:19]
    v_mfma_f32_16x16x32_bf16 v[20:23], v[84:87], v[108:111], v[20:23]
    v_mfma_f32_16x16x32_bf16 v[24:27], v[88:91], v[104:107], v[24:27]
    v_mfma_f32_16x16x32_bf16 v[28:31], v[88:91], v[108:111], v[28:31]
    v_mfma_f32_16x16x32_bf16 v[32:35], v[92:95], v[104:107], v[32:35]
    v_mfma_f32_16x16x32_bf16 v[36:39], v[92:95], v[108:111], v[36:39]
    v_mfma_f32_16x16x32_bf16 v[40:43], v[96:99], v[104:107], v[40:43]
    v_mfma_f32_16x16x32_bf16 v[44:47], v[96:99], v[108:111], v[44:47]
    v_mfma_f32_16x16x32_bf16 v[48:51], v[100:103], v[104:107], v[48:51]
    v_mfma_f32_16x16x32_bf16 v[52:55], v[100:103], v[108:111], v[52:55]
    s_waitcnt lgkmcnt(7)
    s_barrier
    s_waitcnt vmcnt(20)
    ds_write_b128 v5, v[192:195] offset:20736
    ds_write_b128 v5, v[196:199] offset:25344
    s_mov_b64 s[42:43], exec
    s_mov_b64 exec, s[40:41]
    ds_write_b128 v5, v[200:203] offset:29952
    s_mov_b64 exec, s[42:43]
    ds_write_b128 v5, v[204:207] offset:32256
    ds_write_b128 v5, v[208:211] offset:36864
    s_waitcnt lgkmcnt(6)
    ds_read_b128 v[84:87], v8 offset:0
    ds_read_b128 v[88:91], v8 offset:2304
    ds_read_b128 v[92:95], v8 offset:4608
    ds_read_b128 v[96:99], v8 offset:6912
    ds_read_b128 v[100:103], v8 offset:9216
    ds_read_b128 v[104:107], v9 offset:11520
    ds_read_b128 v[108:111], v9 offset:13824
    v_mfma_f32_16x16x32_bf16 v[16:19], v[56:59], v[76:79], v[16:19]
    v_mfma_f32_16x16x32_bf16 v[20:23], v[56:59], v[80:83], v[20:23]
    v_mfma_f32_16x16x32_bf16 v[24:27], v[60:63], v[76:79], v[24:27]
    v_mfma_f32_16x16x32_bf16 v[28:31], v[60:63], v[80:83], v[28:31]
    v_mfma_f32_16x16x32_bf16 v[32:35], v[64:67], v[76:79], v[32:35]
    v_mfma_f32_16x16x32_bf16 v[36:39], v[64:67], v[80:83], v[36:39]
    v_mfma_f32_16x16x32_bf16 v[40:43], v[68:71], v[76:79], v[40:43]
    v_mfma_f32_16x16x32_bf16 v[44:47], v[68:71], v[80:83], v[44:47]
    v_mfma_f32_16x16x32_bf16 v[48:51], v[72:75], v[76:79], v[48:51]
    v_mfma_f32_16x16x32_bf16 v[52:55], v[72:75], v[80:83], v[52:55]
    s_waitcnt lgkmcnt(7)
    s_barrier
    s_waitcnt vmcnt(15)
    ds_write_b128 v5, v[212:215] offset:41472
    ds_write_b128 v5, v[216:219] offset:46080
    s_mov_b64 s[42:43], exec
    s_mov_b64 exec, s[40:41]
    ds_write_b128 v5, v[220:223] offset:50688
    s_mov_b64 exec, s[42:43]
    ds_write_b128 v5, v[224:227] offset:52992
    ds_write_b128 v5, v[228:231] offset:57600
    s_waitcnt lgkmcnt(6)
    ds_read_b128 v[56:59], v8 offset:20736
    ds_read_b128 v[60:63], v8 offset:23040
    ds_read_b128 v[64:67], v8 offset:25344
    ds_read_b128 v[68:71], v8 offset:27648
    ds_read_b128 v[72:75], v8 offset:29952
    ds_read_b128 v[76:79], v9 offset:32256
    ds_read_b128 v[80:83], v9 offset:34560
    v_mfma_f32_16x16x32_bf16 v[16:19], v[84:87], v[104:107], v[16:19]
    v_mfma_f32_16x16x32_bf16 v[20:23], v[84:87], v[108:111], v[20:23]
    v_mfma_f32_16x16x32_bf16 v[24:27], v[88:91], v[104:107], v[24:27]
    v_mfma_f32_16x16x32_bf16 v[28:31], v[88:91], v[108:111], v[28:31]
    v_mfma_f32_16x16x32_bf16 v[32:35], v[92:95], v[104:107], v[32:35]
    v_mfma_f32_16x16x32_bf16 v[36:39], v[92:95], v[108:111], v[36:39]
    v_mfma_f32_16x16x32_bf16 v[40:43], v[96:99], v[104:107], v[40:43]
    v_mfma_f32_16x16x32_bf16 v[44:47], v[96:99], v[108:111], v[44:47]
    v_mfma_f32_16x16x32_bf16 v[48:51], v[100:103], v[104:107], v[48:51]
    v_mfma_f32_16x16x32_bf16 v[52:55], v[100:103], v[108:111], v[52:55]
    s_waitcnt lgkmcnt(7)
    s_barrier
    s_waitcnt vmcnt(10)
    ds_write_b128 v5, v[112:115] offset:0
    ds_write_b128 v5, v[116:119] offset:4608
    s_mov_b64 s[42:43], exec
    s_mov_b64 exec, s[40:41]
    ds_write_b128 v5, v[120:123] offset:9216
    s_mov_b64 exec, s[42:43]
    ds_write_b128 v5, v[124:127] offset:11520
    ds_write_b128 v5, v[128:131] offset:16128
    s_waitcnt lgkmcnt(6)
    ds_read_b128 v[84:87], v8 offset:41472
    ds_read_b128 v[88:91], v8 offset:43776
    ds_read_b128 v[92:95], v8 offset:46080
    ds_read_b128 v[96:99], v8 offset:48384
    ds_read_b128 v[100:103], v8 offset:50688
    ds_read_b128 v[104:107], v9 offset:52992
    ds_read_b128 v[108:111], v9 offset:55296
    v_mfma_f32_16x16x32_bf16 v[16:19], v[56:59], v[76:79], v[16:19]
    v_mfma_f32_16x16x32_bf16 v[20:23], v[56:59], v[80:83], v[20:23]
    v_mfma_f32_16x16x32_bf16 v[24:27], v[60:63], v[76:79], v[24:27]
    v_mfma_f32_16x16x32_bf16 v[28:31], v[60:63], v[80:83], v[28:31]
    v_mfma_f32_16x16x32_bf16 v[32:35], v[64:67], v[76:79], v[32:35]
    v_mfma_f32_16x16x32_bf16 v[36:39], v[64:67], v[80:83], v[36:39]
    v_mfma_f32_16x16x32_bf16 v[40:43], v[68:71], v[76:79], v[40:43]
    v_mfma_f32_16x16x32_bf16 v[44:47], v[68:71], v[80:83], v[44:47]
    v_mfma_f32_16x16x32_bf16 v[48:51], v[72:75], v[76:79], v[48:51]
    v_mfma_f32_16x16x32_bf16 v[52:55], v[72:75], v[80:83], v[52:55]
    s_waitcnt lgkmcnt(7)
    s_barrier
    s_waitcnt vmcnt(5)
    ds_write_b128 v5, v[132:135] offset:20736
    ds_write_b128 v5, v[136:139] offset:25344
    s_mov_b64 s[42:43], exec
    s_mov_b64 exec, s[40:41]
    ds_write_b128 v5, v[140:143] offset:29952
    s_mov_b64 exec, s[42:43]
    ds_write_b128 v5, v[144:147] offset:32256
    ds_write_b128 v5, v[148:151] offset:36864
    s_waitcnt lgkmcnt(6)
    ds_read_b128 v[56:59], v8 offset:0
    ds_read_b128 v[60:63], v8 offset:2304
    ds_read_b128 v[64:67], v8 offset:4608
    ds_read_b128 v[68:71], v8 offset:6912
    ds_read_b128 v[72:75], v8 offset:9216
    ds_read_b128 v[76:79], v9 offset:11520
    ds_read_b128 v[80:83], v9 offset:13824
    v_mfma_f32_16x16x32_bf16 v[16:19], v[84:87], v[104:107], v[16:19]
    v_mfma_f32_16x16x32_bf16 v[20:23], v[84:87], v[108:111], v[20:23]
    v_mfma_f32_16x16x32_bf16 v[24:27], v[88:91], v[104:107], v[24:27]
    v_mfma_f32_16x16x32_bf16 v[28:31], v[88:91], v[108:111], v[28:31]
    v_mfma_f32_16x16x32_bf16 v[32:35], v[92:95], v[104:107], v[32:35]
    v_mfma_f32_16x16x32_bf16 v[36:39], v[92:95], v[108:111], v[36:39]
    v_mfma_f32_16x16x32_bf16 v[40:43], v[96:99], v[104:107], v[40:43]
    v_mfma_f32_16x16x32_bf16 v[44:47], v[96:99], v[108:111], v[44:47]
    v_mfma_f32_16x16x32_bf16 v[48:51], v[100:103], v[104:107], v[48:51]
    v_mfma_f32_16x16x32_bf16 v[52:55], v[100:103], v[108:111], v[52:55]
    s_waitcnt lgkmcnt(7)
    s_barrier
    s_waitcnt vmcnt(0)
    ds_write_b128 v5, v[152:155] offset:41472
    ds_write_b128 v5, v[156:159] offset:46080
    s_mov_b64 s[42:43], exec
    s_mov_b64 exec, s[40:41]
    ds_write_b128 v5, v[160:163] offset:50688
    s_mov_b64 exec, s[42:43]
    ds_write_b128 v5, v[164:167] offset:52992
    ds_write_b128 v5, v[168:171] offset:57600
    s_waitcnt lgkmcnt(6)
    ds_read_b128 v[84:87], v8 offset:20736
    ds_read_b128 v[88:91], v8 offset:23040
    ds_read_b128 v[92:95], v8 offset:25344
    ds_read_b128 v[96:99], v8 offset:27648
    ds_read_b128 v[100:103], v8 offset:29952
    ds_read_b128 v[104:107], v9 offset:32256
    ds_read_b128 v[108:111], v9 offset:34560
    v_mfma_f32_16x16x32_bf16 v[16:19], v[56:59], v[76:79], v[16:19]
    v_mfma_f32_16x16x32_bf16 v[20:23], v[56:59], v[80:83], v[20:23]
    v_mfma_f32_16x16x32_bf16 v[24:27], v[60:63], v[76:79], v[24:27]
    v_mfma_f32_16x16x32_bf16 v[28:31], v[60:63], v[80:83], v[28:31]
    v_mfma_f32_16x16x32_bf16 v[32:35], v[64:67], v[76:79], v[32:35]
    v_mfma_f32_16x16x32_bf16 v[36:39], v[64:67], v[80:83], v[36:39]
    v_mfma_f32_16x16x32_bf16 v[40:43], v[68:71], v[76:79], v[40:43]
    v_mfma_f32_16x16x32_bf16 v[44:47], v[68:71], v[80:83], v[44:47]
    v_mfma_f32_16x16x32_bf16 v[48:51], v[72:75], v[76:79], v[48:51]
    v_mfma_f32_16x16x32_bf16 v[52:55], v[72:75], v[80:83], v[52:55]
    s_waitcnt lgkmcnt(7)
    s_barrier
    s_waitcnt lgkmcnt(0)
    ds_read_b128 v[56:59], v8 offset:41472
    ds_read_b128 v[60:63], v8 offset:43776
    ds_read_b128 v[64:67], v8 offset:46080
    ds_read_b128 v[68:71], v8 offset:48384
    ds_read_b128 v[72:75], v8 offset:50688
    ds_read_b128 v[76:79], v9 offset:52992
    ds_read_b128 v[80:83], v9 offset:55296
    v_mfma_f32_16x16x32_bf16 v[16:19], v[84:87], v[104:107], v[16:19]
    v_mfma_f32_16x16x32_bf16 v[20:23], v[84:87], v[108:111], v[20:23]
    v_mfma_f32_16x16x32_bf16 v[24:27], v[88:91], v[104:107], v[24:27]
    v_mfma_f32_16x16x32_bf16 v[28:31], v[88:91], v[108:111], v[28:31]
    v_mfma_f32_16x16x32_bf16 v[32:35], v[92:95], v[104:107], v[32:35]
    v_mfma_f32_16x16x32_bf16 v[36:39], v[92:95], v[108:111], v[36:39]
    v_mfma_f32_16x16x32_bf16 v[40:43], v[96:99], v[104:107], v[40:43]
    v_mfma_f32_16x16x32_bf16 v[44:47], v[96:99], v[108:111], v[44:47]
    v_mfma_f32_16x16x32_bf16 v[48:51], v[100:103], v[104:107], v[48:51]
    v_mfma_f32_16x16x32_bf16 v[52:55], v[100:103], v[108:111], v[52:55]
    s_waitcnt lgkmcnt(0)
    v_mfma_f32_16x16x32_bf16 v[16:19], v[56:59], v[76:79], v[16:19]
    v_mfma_f32_16x16x32_bf16 v[20:23], v[56:59], v[80:83], v[20:23]
    v_mfma_f32_16x16x32_bf16 v[24:27], v[60:63], v[76:79], v[24:27]
    v_mfma_f32_16x16x32_bf16 v[28:31], v[60:63], v[80:83], v[28:31]
    v_mfma_f32_16x16x32_bf16 v[32:35], v[64:67], v[76:79], v[32:35]
    v_mfma_f32_16x16x32_bf16 v[36:39], v[64:67], v[80:83], v[36:39]
    v_mfma_f32_16x16x32_bf16 v[40:43], v[68:71], v[76:79], v[40:43]
    v_mfma_f32_16x16x32_bf16 v[44:47], v[68:71], v[80:83], v[44:47]
    v_mfma_f32_16x16x32_bf16 v[48:51], v[72:75], v[76:79], v[48:51]
    v_mfma_f32_16x16x32_bf16 v[52:55], v[72:75], v[80:83], v[52:55]
    s_lshl_b32 s49, s9, 6
    s_lshl_b32 s50, s12, 5
    s_add_u32 s49, s49, s50
    s_lshl_b32 s50, s11, 4
    s_add_u32 s49, s49, s50
    v_add_u32 v6, s49, v2
    v_lshlrev_b32 v7, 2, v6
    buffer_load_dword v10, v7, s[28:31], 0 offen
    s_mul_i32 s50, s10, 80
    v_lshlrev_b32 v11, 2, v3
    v_add_u32 v11, s50, v11
    v_lshlrev_b32 v11, 11, v11
    v_add_u32 v11, v11, v6
    v_lshlrev_b32 v11, 1, v11

    s_barrier
    v_lshrrev_b32 v140, 3, v0
    v_and_b32 v141, 7, v0
    v_mul_u32_u24 v11, 144, v140
    v_lshl_add_u32 v11, v141, 4, v11
    ds_write_b128 v11, v[236:239] offset:40960
    ds_write_b128 v11, v[240:243] offset:45568
    s_mov_b64 s[42:43], exec
    s_mov_b64 exec, s[40:41]
    ds_write_b128 v11, v[244:247] offset:50176
    s_mov_b64 exec, s[42:43]

    s_nop 7
    v_lshlrev_b32 v12, 4, v1
    s_lshl_b32 s50, s8, 13
    v_add_u32 v12, s50, v12
    s_xor_b32 s51, s8, 2
    s_lshl_b32 s51, s51, 13
    v_lshlrev_b32 v13, 4, v1
    v_add_u32 v13, s51, v13
    s_cmp_eq_u32 s11, 0
    s_cbranch_scc0 k2_wk1

    ds_write_b128 v12, v[20:23] offset:0
    ds_write_b128 v12, v[28:31] offset:1024
    ds_write_b128 v12, v[36:39] offset:2048
    ds_write_b128 v12, v[44:47] offset:3072
    ds_write_b128 v12, v[52:55] offset:4096
    s_branch k2_wkj
k2_wk1:
    ds_write_b128 v12, v[16:19] offset:0
    ds_write_b128 v12, v[24:27] offset:1024
    ds_write_b128 v12, v[32:35] offset:2048
    ds_write_b128 v12, v[40:43] offset:3072
    ds_write_b128 v12, v[48:51] offset:4096
    v_mov_b32 v16, v20
    v_mov_b32 v17, v21
    v_mov_b32 v18, v22
    v_mov_b32 v19, v23
    v_mov_b32 v24, v28
    v_mov_b32 v25, v29
    v_mov_b32 v26, v30
    v_mov_b32 v27, v31
    v_mov_b32 v32, v36
    v_mov_b32 v33, v37
    v_mov_b32 v34, v38
    v_mov_b32 v35, v39
    v_mov_b32 v40, v44
    v_mov_b32 v41, v45
    v_mov_b32 v42, v46
    v_mov_b32 v43, v47
    v_mov_b32 v48, v52
    v_mov_b32 v49, v53
    v_mov_b32 v50, v54
    v_mov_b32 v51, v55
k2_wkj:
    s_waitcnt lgkmcnt(0)
    s_barrier
    v_mul_u32_u24 v14, 640, v6
    s_mul_i32 s50, s10, 80
    v_lshlrev_b32 v15, 2, v3
    v_add3_u32 v14, v14, v15, s50
    v_lshlrev_b32 v14, 1, v14
    s_waitcnt vmcnt(0)
    v_sub_f32 v15, 1.0, v10
    v_cvt_pk_bf16_f32 v15, v15, v15
    v_lshlrev_b32 v15, 16, v15

    v_mul_u32_u24 v11, 576, v3
    s_lshl_b32 s50, s12, 5
    s_lshl_b32 s51, s11, 4
    s_add_u32 s50, s50, s51
    v_add_u32 v141, s50, v2
    v_lshl_add_u32 v11, v141, 1, v11

    ds_read_u16 v112, v11 offset:40960
    ds_read_u16 v113, v11 offset:41104
    ds_read_u16 v114, v11 offset:41248
    ds_read_u16 v115, v11 offset:41392
    ds_read_u16 v116, v11 offset:43264
    ds_read_u16 v117, v11 offset:43408
    ds_read_u16 v118, v11 offset:43552
    ds_read_u16 v119, v11 offset:43696
    ds_read_u16 v120, v11 offset:45568
    ds_read_u16 v121, v11 offset:45712
    ds_read_u16 v122, v11 offset:45856
    ds_read_u16 v123, v11 offset:46000
    ds_read_u16 v124, v11 offset:47872
    ds_read_u16 v125, v11 offset:48016
    ds_read_u16 v126, v11 offset:48160
    ds_read_u16 v127, v11 offset:48304
    ds_read_u16 v128, v11 offset:50176
    ds_read_u16 v129, v11 offset:50320
    ds_read_u16 v130, v11 offset:50464
    ds_read_u16 v131, v11 offset:50608
    ds_read_b128 v[144:147], v13 offset:0
    s_waitcnt lgkmcnt(0)
    v_add_f32 v140, v16, v144
    v_add_f32 v141, v17, v145
    v_add_f32 v142, v18, v146
    v_add_f32 v143, v19, v147
    v_cvt_pk_bf16_f32 v156, v140, v141
    v_cvt_pk_bf16_f32 v157, v142, v143
    v_lshlrev_b32 v140, 16, v156
    v_and_b32 v141, 0xffff0000, v156
    v_lshlrev_b32 v142, 16, v157
    v_and_b32 v143, 0xffff0000, v157
    v_mul_f32 v140, v15, v140
    v_mul_f32 v141, v15, v141
    v_mul_f32 v142, v15, v142
    v_mul_f32 v143, v15, v143
    v_lshlrev_b32 v144, 16, v112
    v_mul_f32 v144, v10, v144
    v_lshlrev_b32 v145, 16, v113
    v_mul_f32 v145, v10, v145
    v_lshlrev_b32 v146, 16, v114
    v_mul_f32 v146, v10, v146
    v_lshlrev_b32 v147, 16, v115
    v_mul_f32 v147, v10, v147
    v_cvt_pk_bf16_f32 v156, v140, v141
    v_lshlrev_b32 v140, 16, v156
    v_and_b32 v141, 0xffff0000, v156
    v_cvt_pk_bf16_f32 v156, v144, v145
    v_lshlrev_b32 v144, 16, v156
    v_and_b32 v145, 0xffff0000, v156
    v_cvt_pk_bf16_f32 v156, v142, v143
    v_lshlrev_b32 v142, 16, v156
    v_and_b32 v143, 0xffff0000, v156
    v_cvt_pk_bf16_f32 v156, v146, v147
    v_lshlrev_b32 v146, 16, v156
    v_and_b32 v147, 0xffff0000, v156
    v_add_f32 v140, v140, v144
    v_add_f32 v141, v141, v145
    v_add_f32 v142, v142, v146
    v_add_f32 v143, v143, v147
    v_cvt_pk_bf16_f32 v156, v140, v141
    v_cvt_pk_bf16_f32 v157, v142, v143
    buffer_store_dwordx2 v[156:157], v14, s[32:35], 0 offen offset:0
    ds_read_b128 v[144:147], v13 offset:1024
    s_waitcnt lgkmcnt(0)
    v_add_f32 v140, v24, v144
    v_add_f32 v141, v25, v145
    v_add_f32 v142, v26, v146
    v_add_f32 v143, v27, v147
    v_cvt_pk_bf16_f32 v156, v140, v141
    v_cvt_pk_bf16_f32 v157, v142, v143
    v_lshlrev_b32 v140, 16, v156
    v_and_b32 v141, 0xffff0000, v156
    v_lshlrev_b32 v142, 16, v157
    v_and_b32 v143, 0xffff0000, v157
    v_mul_f32 v140, v15, v140
    v_mul_f32 v141, v15, v141
    v_mul_f32 v142, v15, v142
    v_mul_f32 v143, v15, v143
    v_lshlrev_b32 v144, 16, v116
    v_mul_f32 v144, v10, v144
    v_lshlrev_b32 v145, 16, v117
    v_mul_f32 v145, v10, v145
    v_lshlrev_b32 v146, 16, v118
    v_mul_f32 v146, v10, v146
    v_lshlrev_b32 v147, 16, v119
    v_mul_f32 v147, v10, v147
    v_cvt_pk_bf16_f32 v156, v140, v141
    v_lshlrev_b32 v140, 16, v156
    v_and_b32 v141, 0xffff0000, v156
    v_cvt_pk_bf16_f32 v156, v144, v145
    v_lshlrev_b32 v144, 16, v156
    v_and_b32 v145, 0xffff0000, v156
    v_cvt_pk_bf16_f32 v156, v142, v143
    v_lshlrev_b32 v142, 16, v156
    v_and_b32 v143, 0xffff0000, v156
    v_cvt_pk_bf16_f32 v156, v146, v147
    v_lshlrev_b32 v146, 16, v156
    v_and_b32 v147, 0xffff0000, v156
    v_add_f32 v140, v140, v144
    v_add_f32 v141, v141, v145
    v_add_f32 v142, v142, v146
    v_add_f32 v143, v143, v147
    v_cvt_pk_bf16_f32 v156, v140, v141
    v_cvt_pk_bf16_f32 v157, v142, v143
    buffer_store_dwordx2 v[156:157], v14, s[32:35], 0 offen offset:32
    ds_read_b128 v[144:147], v13 offset:2048
    s_waitcnt lgkmcnt(0)
    v_add_f32 v140, v32, v144
    v_add_f32 v141, v33, v145
    v_add_f32 v142, v34, v146
    v_add_f32 v143, v35, v147
    v_cvt_pk_bf16_f32 v156, v140, v141
    v_cvt_pk_bf16_f32 v157, v142, v143
    v_lshlrev_b32 v140, 16, v156
    v_and_b32 v141, 0xffff0000, v156
    v_lshlrev_b32 v142, 16, v157
    v_and_b32 v143, 0xffff0000, v157
    v_mul_f32 v140, v15, v140
    v_mul_f32 v141, v15, v141
    v_mul_f32 v142, v15, v142
    v_mul_f32 v143, v15, v143
    v_lshlrev_b32 v144, 16, v120
    v_mul_f32 v144, v10, v144
    v_lshlrev_b32 v145, 16, v121
    v_mul_f32 v145, v10, v145
    v_lshlrev_b32 v146, 16, v122
    v_mul_f32 v146, v10, v146
    v_lshlrev_b32 v147, 16, v123
    v_mul_f32 v147, v10, v147
    v_cvt_pk_bf16_f32 v156, v140, v141
    v_lshlrev_b32 v140, 16, v156
    v_and_b32 v141, 0xffff0000, v156
    v_cvt_pk_bf16_f32 v156, v144, v145
    v_lshlrev_b32 v144, 16, v156
    v_and_b32 v145, 0xffff0000, v156
    v_cvt_pk_bf16_f32 v156, v142, v143
    v_lshlrev_b32 v142, 16, v156
    v_and_b32 v143, 0xffff0000, v156
    v_cvt_pk_bf16_f32 v156, v146, v147
    v_lshlrev_b32 v146, 16, v156
    v_and_b32 v147, 0xffff0000, v156
    v_add_f32 v140, v140, v144
    v_add_f32 v141, v141, v145
    v_add_f32 v142, v142, v146
    v_add_f32 v143, v143, v147
    v_cvt_pk_bf16_f32 v156, v140, v141
    v_cvt_pk_bf16_f32 v157, v142, v143
    buffer_store_dwordx2 v[156:157], v14, s[32:35], 0 offen offset:64
    ds_read_b128 v[144:147], v13 offset:3072
    s_waitcnt lgkmcnt(0)
    v_add_f32 v140, v40, v144
    v_add_f32 v141, v41, v145
    v_add_f32 v142, v42, v146
    v_add_f32 v143, v43, v147
    v_cvt_pk_bf16_f32 v156, v140, v141
    v_cvt_pk_bf16_f32 v157, v142, v143
    v_lshlrev_b32 v140, 16, v156
    v_and_b32 v141, 0xffff0000, v156
    v_lshlrev_b32 v142, 16, v157
    v_and_b32 v143, 0xffff0000, v157
    v_mul_f32 v140, v15, v140
    v_mul_f32 v141, v15, v141
    v_mul_f32 v142, v15, v142
    v_mul_f32 v143, v15, v143
    v_lshlrev_b32 v144, 16, v124
    v_mul_f32 v144, v10, v144
    v_lshlrev_b32 v145, 16, v125
    v_mul_f32 v145, v10, v145
    v_lshlrev_b32 v146, 16, v126
    v_mul_f32 v146, v10, v146
    v_lshlrev_b32 v147, 16, v127
    v_mul_f32 v147, v10, v147
    v_cvt_pk_bf16_f32 v156, v140, v141
    v_lshlrev_b32 v140, 16, v156
    v_and_b32 v141, 0xffff0000, v156
    v_cvt_pk_bf16_f32 v156, v144, v145
    v_lshlrev_b32 v144, 16, v156
    v_and_b32 v145, 0xffff0000, v156
    v_cvt_pk_bf16_f32 v156, v142, v143
    v_lshlrev_b32 v142, 16, v156
    v_and_b32 v143, 0xffff0000, v156
    v_cvt_pk_bf16_f32 v156, v146, v147
    v_lshlrev_b32 v146, 16, v156
    v_and_b32 v147, 0xffff0000, v156
    v_add_f32 v140, v140, v144
    v_add_f32 v141, v141, v145
    v_add_f32 v142, v142, v146
    v_add_f32 v143, v143, v147
    v_cvt_pk_bf16_f32 v156, v140, v141
    v_cvt_pk_bf16_f32 v157, v142, v143
    buffer_store_dwordx2 v[156:157], v14, s[32:35], 0 offen offset:96
    ds_read_b128 v[144:147], v13 offset:4096
    s_waitcnt lgkmcnt(0)
    v_add_f32 v140, v48, v144
    v_add_f32 v141, v49, v145
    v_add_f32 v142, v50, v146
    v_add_f32 v143, v51, v147
    v_cvt_pk_bf16_f32 v156, v140, v141
    v_cvt_pk_bf16_f32 v157, v142, v143
    v_lshlrev_b32 v140, 16, v156
    v_and_b32 v141, 0xffff0000, v156
    v_lshlrev_b32 v142, 16, v157
    v_and_b32 v143, 0xffff0000, v157
    v_mul_f32 v140, v15, v140
    v_mul_f32 v141, v15, v141
    v_mul_f32 v142, v15, v142
    v_mul_f32 v143, v15, v143
    v_lshlrev_b32 v144, 16, v128
    v_mul_f32 v144, v10, v144
    v_lshlrev_b32 v145, 16, v129
    v_mul_f32 v145, v10, v145
    v_lshlrev_b32 v146, 16, v130
    v_mul_f32 v146, v10, v146
    v_lshlrev_b32 v147, 16, v131
    v_mul_f32 v147, v10, v147
    v_cvt_pk_bf16_f32 v156, v140, v141
    v_lshlrev_b32 v140, 16, v156
    v_and_b32 v141, 0xffff0000, v156
    v_cvt_pk_bf16_f32 v156, v144, v145
    v_lshlrev_b32 v144, 16, v156
    v_and_b32 v145, 0xffff0000, v156
    v_cvt_pk_bf16_f32 v156, v142, v143
    v_lshlrev_b32 v142, 16, v156
    v_and_b32 v143, 0xffff0000, v156
    v_cvt_pk_bf16_f32 v156, v146, v147
    v_lshlrev_b32 v146, 16, v156
    v_and_b32 v147, 0xffff0000, v156
    v_add_f32 v140, v140, v144
    v_add_f32 v141, v141, v145
    v_add_f32 v142, v142, v146
    v_add_f32 v143, v143, v147
    v_cvt_pk_bf16_f32 v156, v140, v141
    v_cvt_pk_bf16_f32 v157, v142, v143
    buffer_store_dwordx2 v[156:157], v14, s[32:35], 0 offen offset:128
    s_waitcnt vmcnt(0)
k2_end:
    s_endpgm
.section .rodata,"a"
.p2align 6
.amdhsa_kernel k1_kernel
  .amdhsa_next_free_vgpr 128
  .amdhsa_next_free_sgpr 100
  .amdhsa_accum_offset 128
  .amdhsa_group_segment_fixed_size 0
  .amdhsa_kernarg_size 112
  .amdhsa_user_sgpr_count 2
  .amdhsa_user_sgpr_kernarg_segment_ptr 1
  .amdhsa_system_sgpr_workgroup_id_x 1
.end_amdhsa_kernel
.amdhsa_kernel k2_kernel
  .amdhsa_next_free_vgpr 248
  .amdhsa_next_free_sgpr 100
  .amdhsa_accum_offset 248
  .amdhsa_group_segment_fixed_size 0
  .amdhsa_kernarg_size 112
  .amdhsa_user_sgpr_count 2
  .amdhsa_user_sgpr_kernarg_segment_ptr 1
  .amdhsa_system_sgpr_workgroup_id_x 1
.end_amdhsa_kernel
```
